```python
import torch

def _softmax(x, axis=-1):
    return torch.softmax(x, dim=axis)
def _gelu(x):
    return torch.nn.functional.gelu(x, approximate="tanh")
def _silu(x):
    return torch.nn.functional.silu(x)
def _sigmoid(x):
    return torch.sigmoid(x)
def _layernorm(x, axis=-1, eps=1e-5):
    m = x.mean(dim=axis, keepdim=True)
    v = x.var(dim=axis, keepdim=True, unbiased=False)
    return (x - m) / torch.sqrt(v + eps)
def _scatter_add(tgt, idx, src, axis=0):
    return tgt.clone().index_add_(axis, idx, src)
def _segment_sum(src, seg, n):
    out = torch.zeros((n,) + src.shape[1:], dtype=src.dtype)
    return out.index_add_(0, seg, src)
def _pad(x, pw):
    flat = tuple(v for pair in reversed(pw) for v in pair)
    return torch.nn.functional.pad(x, flat)

kernel_name = 'gated_mix__grouped_kv_mqa__ssm_conv_s5__prompt'

def setup_inputs():

    _w = (lambda a: (lambda t: t.to(torch.bfloat16) if t.is_floating_point() else t)(torch.as_tensor(a)))
    def _A_setup():
        B, S, D, H = 1, 2048, 448, 16
        Dh = D // H
        return {
            "x": _w((lambda *s: torch.randn(*s, dtype=torch.bfloat16) * 0.05)(B, S, D)),
            "wq": _w((lambda *s: torch.randn(*s, dtype=torch.bfloat16) * 1.6)(D, H * Dh)),
            "wk": _w((lambda *s: torch.randn(*s, dtype=torch.bfloat16) * 1.6)(D, Dh)),
            "wv": _w((lambda *s: torch.randn(*s, dtype=torch.bfloat16) * 0.05)(D, Dh)),
            "wo": _w((lambda *s: torch.randn(*s, dtype=torch.bfloat16) * 0.05)(H * Dh, D)),
        }
    _A_in = _A_setup()

    def _B_setup():
        B, S, D = 1, 2048, 448
        P = D
        Lambda_re = -0.5 * (lambda _x: torch.exp(torch.as_tensor(_x)))((lambda *s: torch.randn(*s, dtype=torch.bfloat16) * 0.4)(P))
        Lambda_im = (lambda *s: torch.randn(*s, dtype=torch.bfloat16) * 0.8)(P) * 1.0
        B_re = (lambda *s: torch.randn(*s, dtype=torch.bfloat16) * 0.4)(P, D) * (D ** -0.5)
        B_im = (lambda *s: torch.randn(*s, dtype=torch.bfloat16) * 0.4)(P, D) * (D ** -0.5)
        C_re = (lambda *s: torch.randn(*s, dtype=torch.bfloat16) * 0.4)(D, P) * (P ** -0.5)
        C_im = (lambda *s: torch.randn(*s, dtype=torch.bfloat16) * 0.4)(D, P) * (P ** -0.5)
        log_dt = (lambda *s: torch.randn(*s, dtype=torch.bfloat16) * 0.4)(P) * 0.3 - 2.0
        Dskip = (lambda *s: torch.randn(*s, dtype=torch.bfloat16) * 0.2)(D)
        return {
            "x": _w((lambda *s: torch.randn(*s, dtype=torch.bfloat16) * 0.05)(B, S, D)),
            "Lambda_re": _w(Lambda_re),
            "Lambda_im": _w(Lambda_im),
            "B_re": _w(B_re),
            "B_im": _w(B_im),
            "C_re": _w(C_re),
            "C_im": _w(C_im),
            "log_dt": _w(log_dt),
            "Dskip": _w(Dskip),
        }
    _B_in = _B_setup()

    return {
        "A_x": _A_in["x"],
        "A_wq": _A_in["wq"],
        "A_wk": _A_in["wk"],
        "A_wv": _A_in["wv"],
        "A_wo": _A_in["wo"],
        "B_x": _B_in["x"],
        "B_Lambda_re": _B_in["Lambda_re"],
        "B_Lambda_im": _B_in["Lambda_im"],
        "B_B_re": _B_in["B_re"],
        "B_B_im": _B_in["B_im"],
        "B_C_re": _B_in["C_re"],
        "B_C_im": _B_in["C_im"],
        "B_log_dt": _B_in["log_dt"],
        "B_Dskip": _B_in["Dskip"],
        "gate_w": _w((lambda *s: torch.randn(*s, dtype=torch.bfloat16) * 0.05)(448) * 16.0),
    }

def reference(A_x, A_wq, A_wk, A_wv, A_wo, B_x, B_Lambda_re, B_Lambda_im, B_B_re, B_B_im, B_C_re, B_C_im, B_log_dt, B_Dskip, gate_w):
    def _A_ref(x, wq, wk, wv, wo):
        B, S, D = x.shape
        H = 16
        Dh = D // H
        q = (lambda x, *d: x.permute(*d))((x @ wq).reshape(B, S, H, Dh), 0, 2, 1, 3)
        k = x @ wk
        v = x @ wv
        scores = torch.einsum("bhqd,bkd->bhqk", q, k) * (Dh ** -0.5)
        p = _softmax(scores, axis=-1)
        o = torch.einsum("bhqk,bkd->bhqd", p, v)
        return (lambda x, *d: x.permute(*d))(o, 0, 2, 1, 3).reshape(B, S, H * Dh) @ wo

    def _B_ref(x, Lambda_re, Lambda_im, B_re, B_im, C_re, C_im, log_dt, Dskip):
        Bsz, L, H = x.shape
        Lam = Lambda_re + 1j * Lambda_im
        Bmat = B_re + 1j * B_im
        Cmat = C_re + 1j * C_im
        dt = torch.exp(log_dt)
        Lam_bar = torch.exp(dt * Lam)
        B_bar = ((Lam_bar - 1.0) / Lam)[:, None] * Bmat
        Bu = torch.einsum("bld,pd->blp", x + 0j, B_bar)
        h = torch.zeros_like(Bu[:, 0, :])
        hs = []
        for t in range(L):
            h = Lam_bar[None, :] * h + Bu[:, t, :]
            hs.append(h)
        hseq = torch.stack(hs, 1)
        y = 2.0 * torch.einsum("blp,dp->bld", hseq, Cmat).real + x * Dskip[None, None, :]
        return y

    x = A_x
    g = _sigmoid((x * gate_w).sum(-1, keepdims=True))
    a = _A_ref(x, A_wq, A_wk, A_wv, A_wo)
    b = _B_ref(x, B_Lambda_re, B_Lambda_im, B_B_re, B_B_im, B_C_re, B_C_im, B_log_dt, B_Dskip)
    return g * a + (1 - g) * b
```

```asm
; @launch grid=(256,1,1) block=(512,1,1) lds=163840
.amdgcn_target "amdgcn-amd-amdhsa--gfx950"
.text
.globl gated_mix__grouped_kv_mqa__ssm_conv_s5__prompt_kernel
.p2align 8
.type gated_mix__grouped_kv_mqa__ssm_conv_s5__prompt_kernel,@function
gated_mix__grouped_kv_mqa__ssm_conv_s5__prompt_kernel:
    s_cmp_ge_u32 s2, 256
    s_cbranch_scc1 L_exit
    s_load_dwordx16 s[64:79], s[0:1], 0
    s_load_dwordx16 s[80:95], s[0:1], 64
    s_load_dwordx4 s[96:99], s[0:1], 128
    v_lshrrev_b32 v12, 6, v0
    v_and_b32 v1, 63, v0
    s_and_b32 s48, s2, 7
    v_readfirstlane_b32 s3, v12
    s_lshr_b32 s49, s2, 3
    s_and_b32 s5, s49, 3
    s_and_b32 s50, s48, 1
    s_lshl_b32 s50, s50, 2
    s_add_u32 s5, s5, s50
    s_lshr_b32 s49, s49, 2
    s_lshr_b32 s50, s48, 1
    s_lshl_b32 s4, s50, 3
    s_add_u32 s4, s4, s49
    v_lshlrev_b32 v2, 4, v1
    s_mov_b32 s46, 0
    s_mov_b32 s47, -1
    v_mov_b32 v247, 0
    s_and_b32 s50, s5, 3
    s_lshl_b32 s50, s50, 1
    s_add_u32 s50, s50, s49
    s_cmp_ge_u32 s50, 7
    s_cselect_b32 s51, 7, 0
    s_sub_u32 s50, s50, s51
    s_cmp_ge_u32 s50, 7
    s_cselect_b32 s51, 7, 0
    s_sub_u32 s22, s50, s51
    s_cmp_eq_u32 s5, 7
    s_cselect_b32 s22, 0, s22
    v_lshrrev_b32 v12, 3, v1
    v_and_b32 v13, 7, v1
    v_lshrrev_b32 v14, 4, v1
    v_mul_u32_u24 v15, 896, v12
    v_xor_b32 v14, v13, v14
    v_lshl_add_u32 v4, v14, 4, v15
    v_xor_b32 v14, 4, v14
    v_lshl_add_u32 v5, v14, 4, v15
    v_lshl_add_u32 v11, v13, 4, v15
    v_add_u32 v6, 12288, v4
    v_add_u32 v7, 18432, v5
    v_add_u32 v5, 6144, v5
    s_cmp_ge_u32 s3, 4
    s_cbranch_scc1 L_hw
    v_mov_b32 v248, v4
    v_mov_b32 v249, v5
    v_mov_b32 v250, v6
    v_mov_b32 v251, v7
    s_and_b32 s50, s3, 1
    s_lshr_b32 s51, s3, 1
    s_cmp_eq_u32 s51, 1
    s_cselect_b64 s[52:53], -1, 0
    s_cselect_b32 s44, 0x7f7f7f7f, -1
    s_cselect_b32 s45, 0x7f7f7f7f, -1
    v_mov_b32 v12, v11
    v_cndmask_b32 v4, v4, v12, s[52:53]
    v_add_u32 v12, 6144, v11
    v_cndmask_b32 v5, v5, v12, s[52:53]
    v_add_u32 v12, 12288, v11
    v_cndmask_b32 v6, v6, v12, s[52:53]
    v_add_u32 v12, 18432, v11
    v_cndmask_b32 v7, v7, v12, s[52:53]
    s_lshl_b32 s54, s50, 5
    s_lshl_b32 s55, s4, 6
    s_add_u32 s55, s55, s54
    s_mul_i32 s55, s55, 896
    s_mul_i32 s56, s54, 896
    s_mul_i32 s57, s5, 112
    s_add_u32 s56, s56, s57
    s_lshl_b32 s58, s50, 12
    s_cmp_eq_u32 s51, 0
    s_mov_b32 s59, 57344
    s_cselect_b32 s40, s55, s56
    s_cselect_b32 s41, 128, s59
    s_mov_b32 s59, 24576
    s_cselect_b32 s43, 0x2000, s59
    s_mov_b32 s59, 155648
    s_cselect_b32 s7, 0x7fffffff, s59
    s_cselect_b32 s59, 0, 57344
    s_add_u32 s42, s58, s59
    s_lshl_b32 s57, s5, 6
    s_add_u32 s57, s57, s54
    s_mul_i32 s16, s57, 896
    s_mov_b32 s17, 128
    s_lshl_b32 s59, s3, 12
    s_add_u32 s18, s59, 65536
    s_cmp_eq_u32 s5, 7
    s_cbranch_scc0 L_pa_1
    s_lshl_b32 s16, s50, 11
    s_mov_b32 s17, 3584
    s_lshl_b32 s59, s51, 12
    s_lshl_b32 s60, s50, 11
    s_add_u32 s59, s59, s60
    s_add_u32 s18, s59, 65536
    v_mov_b32 v248, v2
    v_mov_b32 v249, v2
L_pa_1:
    s_mul_i32 s59, s22, s41
    s_add_u32 s40, s40, s59
    s_mul_i32 s59, s22, s17
    s_add_u32 s16, s16, s59
    s_mul_i32 s20, s41, 7
    s_mul_i32 s21, s17, 7
    s_mov_b32 s19, s22
    s_waitcnt lgkmcnt(0)
    s_cmp_eq_u32 s51, 0
    s_cselect_b32 s8, s64, s66
    s_cselect_b32 s9, s65, s67
    s_mov_b32 s59, 0x62000
    s_cselect_b32 s10, 0x1c0000, s59
    s_mov_b32 s11, 0x20000
    s_cmp_eq_u32 s5, 7
    s_cselect_b32 s54, s68, s80
    s_cselect_b32 s55, s69, s81
    s_cselect_b32 s56, s70, s82
    s_cselect_b32 s57, s71, s83
    s_cselect_b32 s14, 0x6200, s59
    s_cmp_eq_u32 s51, 0
    s_cselect_b32 s12, s54, s56
    s_cselect_b32 s13, s55, s57
    s_mov_b32 s15, 0x20000
    s_mov_b32 s32, s92
    s_mov_b32 s33, s93
    s_mov_b32 s34, 0x380
    s_mov_b32 s35, 0x20000
    s_and_b32 s48, s3, 1
    s_lshl_b32 s48, s48, 5
    v_and_b32 v12, 31, v1
    v_add_u32 v12, s48, v12
    v_lshlrev_b32 v10, 7, v12
    v_add_u32 v10, 112, v10
    v_lshlrev_b32 v12, 1, v12
    s_cmp_ge_u32 s3, 2
    s_cselect_b32 s60, -1, 0
    s_mov_b32 s61, 0
    v_mov_b32 v239, v12
    s_cmp_eq_u32 s5, 7
    s_cbranch_scc1 L_a7
    s_mov_b32 m0, s42
    s_mov_b64 exec, s[44:45]
    buffer_load_dwordx4 v4, s[8:11], s40 offen offset:0 lds
    buffer_load_dwordx4 v5, s[8:11], s40 offen offset:1024 lds
    buffer_load_dwordx4 v6, s[8:11], s40 offen offset:2048 lds
    buffer_load_dwordx4 v7, s[8:11], s40 offen offset:3072 lds
    s_mov_b64 exec, -1
    s_mov_b32 m0, s18
    s_nop 0
    buffer_load_dwordx4 v248, s[12:15], s16 offen offset:0 lds
    buffer_load_dwordx4 v249, s[12:15], s16 offen offset:1024 lds
    buffer_load_dwordx4 v250, s[12:15], s16 offen offset:2048 lds
    buffer_load_dwordx4 v251, s[12:15], s16 offen offset:3072 lds
    s_add_u32 s40, s40, s41
    s_add_u32 s16, s16, s17
    s_add_u32 s42, s42, s43
    s_add_u32 s18, s18, 24576
    s_cmp_ge_u32 s42, s7
    s_cselect_b32 s48, 98304, 0
    s_sub_u32 s42, s42, s48
    s_mov_b32 s49, 155648
    s_cmp_ge_u32 s18, s49
    s_cselect_b32 s48, 98304, 0
    s_sub_u32 s18, s18, s48
    s_add_u32 s19, s19, 1
    s_cmp_eq_u32 s19, 7
    s_cselect_b32 s19, 0, s19
    s_cselect_b32 s48, s20, 0
    s_cselect_b32 s49, s21, 0
    s_sub_u32 s40, s40, s48
    s_sub_u32 s16, s16, s49
    s_lshl_b32 s52, s22, 7
    buffer_load_ushort v240, v239, s[32:35], s52 offen
    s_add_u32 s52, s52, 128
    s_cmp_eq_u32 s52, 896
    s_cselect_b32 s52, 0, s52
    buffer_load_ushort v241, v239, s[32:35], s52 offen
    s_add_u32 s52, s52, 128
    s_cmp_eq_u32 s52, 896
    s_cselect_b32 s52, 0, s52
    buffer_load_ushort v242, v239, s[32:35], s52 offen
    s_add_u32 s52, s52, 128
    s_cmp_eq_u32 s52, 896
    s_cselect_b32 s52, 0, s52
    buffer_load_ushort v243, v239, s[32:35], s52 offen
    s_add_u32 s52, s52, 128
    s_cmp_eq_u32 s52, 896
    s_cselect_b32 s52, 0, s52
    buffer_load_ushort v244, v239, s[32:35], s52 offen
    s_add_u32 s52, s52, 128
    s_cmp_eq_u32 s52, 896
    s_cselect_b32 s52, 0, s52
    buffer_load_ushort v245, v239, s[32:35], s52 offen
    s_add_u32 s52, s52, 128
    s_cmp_eq_u32 s52, 896
    s_cselect_b32 s52, 0, s52
    buffer_load_ushort v246, v239, s[32:35], s52 offen
    s_mov_b32 m0, s42
    s_mov_b64 exec, s[44:45]
    buffer_load_dwordx4 v4, s[8:11], s40 offen offset:0 lds
    buffer_load_dwordx4 v5, s[8:11], s40 offen offset:1024 lds
    buffer_load_dwordx4 v6, s[8:11], s40 offen offset:2048 lds
    buffer_load_dwordx4 v7, s[8:11], s40 offen offset:3072 lds
    s_mov_b64 exec, -1
    s_mov_b32 m0, s18
    s_nop 0
    buffer_load_dwordx4 v248, s[12:15], s16 offen offset:0 lds
    buffer_load_dwordx4 v249, s[12:15], s16 offen offset:1024 lds
    buffer_load_dwordx4 v250, s[12:15], s16 offen offset:2048 lds
    buffer_load_dwordx4 v251, s[12:15], s16 offen offset:3072 lds
    s_add_u32 s40, s40, s41
    s_add_u32 s16, s16, s17
    s_add_u32 s42, s42, s43
    s_add_u32 s18, s18, 24576
    s_cmp_ge_u32 s42, s7
    s_cselect_b32 s48, 98304, 0
    s_sub_u32 s42, s42, s48
    s_mov_b32 s49, 155648
    s_cmp_ge_u32 s18, s49
    s_cselect_b32 s48, 98304, 0
    s_sub_u32 s18, s18, s48
    s_add_u32 s19, s19, 1
    s_cmp_eq_u32 s19, 7
    s_cselect_b32 s19, 0, s19
    s_cselect_b32 s48, s20, 0
    s_cselect_b32 s49, s21, 0
    s_sub_u32 s40, s40, s48
    s_sub_u32 s16, s16, s49
    s_mov_b32 m0, s42
    s_mov_b64 exec, s[44:45]
    buffer_load_dwordx4 v4, s[8:11], s40 offen offset:0 lds
    buffer_load_dwordx4 v5, s[8:11], s40 offen offset:1024 lds
    buffer_load_dwordx4 v6, s[8:11], s40 offen offset:2048 lds
    buffer_load_dwordx4 v7, s[8:11], s40 offen offset:3072 lds
    s_mov_b64 exec, -1
    s_mov_b32 m0, s18
    s_nop 0
    buffer_load_dwordx4 v248, s[12:15], s16 offen offset:0 lds
    buffer_load_dwordx4 v249, s[12:15], s16 offen offset:1024 lds
    buffer_load_dwordx4 v250, s[12:15], s16 offen offset:2048 lds
    buffer_load_dwordx4 v251, s[12:15], s16 offen offset:3072 lds
    s_add_u32 s40, s40, s41
    s_add_u32 s16, s16, s17
    s_add_u32 s42, s42, s43
    s_add_u32 s18, s18, 24576
    s_cmp_ge_u32 s42, s7
    s_cselect_b32 s48, 98304, 0
    s_sub_u32 s42, s42, s48
    s_mov_b32 s49, 155648
    s_cmp_ge_u32 s18, s49
    s_cselect_b32 s48, 98304, 0
    s_sub_u32 s18, s18, s48
    s_add_u32 s19, s19, 1
    s_cmp_eq_u32 s19, 7
    s_cselect_b32 s19, 0, s19
    s_cselect_b32 s48, s20, 0
    s_cselect_b32 s49, s21, 0
    s_sub_u32 s40, s40, s48
    s_sub_u32 s16, s16, s49
    s_mov_b32 s24, s98
    s_mov_b32 s25, s99
    s_mov_b32 s26, 0x6f0000
    s_mov_b32 s27, 0x20000
    s_mov_b32 s28, s96
    s_mov_b32 s29, s97
    s_mov_b32 s30, 0x100
    s_mov_b32 s31, 0x20000
    s_cmp_lg_u32 s2, 0
    s_cbranch_scc1 L_non_2
    s_cmp_lg_u32 s3, 0
    s_cbranch_scc1 L_non_2
    s_memrealtime s[50:51]
    s_waitcnt lgkmcnt(0)
    s_or_b32 s50, s50, 1
    v_mov_b32 v12, s50
    v_mov_b32 v13, 124
    s_mov_b64 exec, 1
    buffer_store_dword v12, v13, s[28:31], 0 offen sc1
    s_mov_b64 exec, -1
L_non_2:
    s_waitcnt vmcnt(16)
    v_add_u32 v11, 57344, v10
    s_mov_b64 exec, s[60:61]
    ds_write2_b32 v11, v240, v247 offset0:0 offset1:1
    s_mov_b64 exec, -1
    v_add_u32 v11, 81920, v10
    s_mov_b64 exec, s[60:61]
    ds_write2_b32 v11, v241, v247 offset0:0 offset1:1
    s_mov_b64 exec, -1
    v_add_u32 v11, 106496, v10
    s_mov_b64 exec, s[60:61]
    ds_write2_b32 v11, v242, v247 offset0:0 offset1:1
    s_mov_b64 exec, -1
    s_waitcnt lgkmcnt(0)
    s_barrier
    s_mov_b32 m0, s42
    s_mov_b64 exec, s[44:45]
    buffer_load_dwordx4 v4, s[8:11], s40 offen offset:0 lds
    buffer_load_dwordx4 v5, s[8:11], s40 offen offset:1024 lds
    buffer_load_dwordx4 v6, s[8:11], s40 offen offset:2048 lds
    buffer_load_dwordx4 v7, s[8:11], s40 offen offset:3072 lds
    s_mov_b64 exec, -1
    s_mov_b32 m0, s18
    s_nop 0
    buffer_load_dwordx4 v248, s[12:15], s16 offen offset:0 lds
    buffer_load_dwordx4 v249, s[12:15], s16 offen offset:1024 lds
    buffer_load_dwordx4 v250, s[12:15], s16 offen offset:2048 lds
    buffer_load_dwordx4 v251, s[12:15], s16 offen offset:3072 lds
    s_add_u32 s40, s40, s41
    s_add_u32 s16, s16, s17
    s_add_u32 s42, s42, s43
    s_add_u32 s18, s18, 24576
    s_cmp_ge_u32 s42, s7
    s_cselect_b32 s48, 98304, 0
    s_sub_u32 s42, s42, s48
    s_mov_b32 s49, 155648
    s_cmp_ge_u32 s18, s49
    s_cselect_b32 s48, 98304, 0
    s_sub_u32 s18, s18, s48
    s_add_u32 s19, s19, 1
    s_cmp_eq_u32 s19, 7
    s_cselect_b32 s19, 0, s19
    s_cselect_b32 s48, s20, 0
    s_cselect_b32 s49, s21, 0
    s_sub_u32 s40, s40, s48
    s_sub_u32 s16, s16, s49
    v_add_u32 v11, 131072, v10
    s_mov_b64 exec, s[60:61]
    ds_write2_b32 v11, v243, v247 offset0:0 offset1:1
    s_mov_b64 exec, -1
    s_waitcnt vmcnt(16)
    s_waitcnt lgkmcnt(0)
    s_barrier
    s_mov_b32 m0, s42
    s_mov_b64 exec, s[44:45]
    buffer_load_dwordx4 v4, s[8:11], s40 offen offset:0 lds
    buffer_load_dwordx4 v5, s[8:11], s40 offen offset:1024 lds
    buffer_load_dwordx4 v6, s[8:11], s40 offen offset:2048 lds
    buffer_load_dwordx4 v7, s[8:11], s40 offen offset:3072 lds
    s_mov_b64 exec, -1
    s_mov_b32 m0, s18
    s_nop 0
    buffer_load_dwordx4 v248, s[12:15], s16 offen offset:0 lds
    buffer_load_dwordx4 v249, s[12:15], s16 offen offset:1024 lds
    buffer_load_dwordx4 v250, s[12:15], s16 offen offset:2048 lds
    buffer_load_dwordx4 v251, s[12:15], s16 offen offset:3072 lds
    s_add_u32 s40, s40, s41
    s_add_u32 s16, s16, s17
    s_add_u32 s42, s42, s43
    s_add_u32 s18, s18, 24576
    s_cmp_ge_u32 s42, s7
    s_cselect_b32 s48, 98304, 0
    s_sub_u32 s42, s42, s48
    s_mov_b32 s49, 155648
    s_cmp_ge_u32 s18, s49
    s_cselect_b32 s48, 98304, 0
    s_sub_u32 s18, s18, s48
    s_add_u32 s19, s19, 1
    s_cmp_eq_u32 s19, 7
    s_cselect_b32 s19, 0, s19
    s_cselect_b32 s48, s20, 0
    s_cselect_b32 s49, s21, 0
    s_sub_u32 s40, s40, s48
    s_sub_u32 s16, s16, s49
    v_add_u32 v11, 57344, v10
    s_mov_b64 exec, s[60:61]
    ds_write2_b32 v11, v244, v247 offset0:0 offset1:1
    s_mov_b64 exec, -1
    s_waitcnt vmcnt(16)
    s_waitcnt lgkmcnt(0)
    s_barrier
    s_mov_b32 m0, s42
    s_mov_b64 exec, s[44:45]
    buffer_load_dwordx4 v4, s[8:11], s40 offen offset:0 lds
    buffer_load_dwordx4 v5, s[8:11], s40 offen offset:1024 lds
    buffer_load_dwordx4 v6, s[8:11], s40 offen offset:2048 lds
    buffer_load_dwordx4 v7, s[8:11], s40 offen offset:3072 lds
    s_mov_b64 exec, -1
    s_mov_b32 m0, s18
    s_nop 0
    buffer_load_dwordx4 v248, s[12:15], s16 offen offset:0 lds
    buffer_load_dwordx4 v249, s[12:15], s16 offen offset:1024 lds
    buffer_load_dwordx4 v250, s[12:15], s16 offen offset:2048 lds
    buffer_load_dwordx4 v251, s[12:15], s16 offen offset:3072 lds
    s_add_u32 s40, s40, s41
    s_add_u32 s16, s16, s17
    s_add_u32 s42, s42, s43
    s_add_u32 s18, s18, 24576
    s_cmp_ge_u32 s42, s7
    s_cselect_b32 s48, 98304, 0
    s_sub_u32 s42, s42, s48
    s_mov_b32 s49, 155648
    s_cmp_ge_u32 s18, s49
    s_cselect_b32 s48, 98304, 0
    s_sub_u32 s18, s18, s48
    s_add_u32 s19, s19, 1
    s_cmp_eq_u32 s19, 7
    s_cselect_b32 s19, 0, s19
    s_cselect_b32 s48, s20, 0
    s_cselect_b32 s49, s21, 0
    s_sub_u32 s40, s40, s48
    s_sub_u32 s16, s16, s49
    v_add_u32 v11, 81920, v10
    s_mov_b64 exec, s[60:61]
    ds_write2_b32 v11, v245, v247 offset0:0 offset1:1
    s_mov_b64 exec, -1
    s_waitcnt vmcnt(16)
    s_waitcnt lgkmcnt(0)
    s_barrier
    s_mov_b32 m0, s42
    s_mov_b64 exec, s[44:45]
    buffer_load_dwordx4 v4, s[8:11], s40 offen offset:0 lds
    buffer_load_dwordx4 v5, s[8:11], s40 offen offset:1024 lds
    buffer_load_dwordx4 v6, s[8:11], s40 offen offset:2048 lds
    buffer_load_dwordx4 v7, s[8:11], s40 offen offset:3072 lds
    s_mov_b64 exec, -1
    s_mov_b32 m0, s18
    s_nop 0
    buffer_load_dwordx4 v248, s[12:15], s16 offen offset:0 lds
    buffer_load_dwordx4 v249, s[12:15], s16 offen offset:1024 lds
    buffer_load_dwordx4 v250, s[12:15], s16 offen offset:2048 lds
    buffer_load_dwordx4 v251, s[12:15], s16 offen offset:3072 lds
    s_add_u32 s40, s40, s41
    s_add_u32 s16, s16, s17
    s_add_u32 s42, s42, s43
    s_add_u32 s18, s18, 24576
    s_cmp_ge_u32 s42, s7
    s_cselect_b32 s48, 98304, 0
    s_sub_u32 s42, s42, s48
    s_mov_b32 s49, 155648
    s_cmp_ge_u32 s18, s49
    s_cselect_b32 s48, 98304, 0
    s_sub_u32 s18, s18, s48
    s_add_u32 s19, s19, 1
    s_cmp_eq_u32 s19, 7
    s_cselect_b32 s19, 0, s19
    s_cselect_b32 s48, s20, 0
    s_cselect_b32 s49, s21, 0
    s_sub_u32 s40, s40, s48
    s_sub_u32 s16, s16, s49
    v_add_u32 v11, 106496, v10
    s_mov_b64 exec, s[60:61]
    ds_write2_b32 v11, v246, v247 offset0:0 offset1:1
    s_mov_b64 exec, -1
    s_waitcnt vmcnt(16)
    s_waitcnt lgkmcnt(0)
    s_barrier
    s_waitcnt vmcnt(8)
    s_waitcnt lgkmcnt(0)
    s_barrier
    s_cmp_eq_u32 s3, 0
    s_cbranch_scc0 L_nw_3
    v_mov_b32 v12, 124
    s_mov_b32 s48, 0x100000
L_pn_4:
    buffer_load_dword v13, v12, s[28:31], 0 offen sc1
    s_waitcnt vmcnt(0)
    v_readfirstlane_b32 s6, v13
    s_sub_u32 s48, s48, 1
    s_cbranch_scc1 L_pnd_5
    s_cmp_eq_u32 s6, 0
    s_cbranch_scc1 L_pn_4
L_pnd_5:
    v_mov_b32 v12, 159232
    v_mov_b32 v13, s6
    ds_write_b32 v12, v13
L_nw_3:
    s_waitcnt vmcnt(0)
    s_waitcnt lgkmcnt(0)
    s_barrier
    s_branch L_aq
L_a7:
    s_cmp_ge_u32 s3, 2
    s_cbranch_scc1 L7_w
    s_add_u32 m0, s42, 0
    s_add_u32 s48, s40, 0
    buffer_load_dwordx4 v4, s[8:11], s48 offen offset:0 lds
    buffer_load_dwordx4 v5, s[8:11], s48 offen offset:1024 lds
    buffer_load_dwordx4 v6, s[8:11], s48 offen offset:2048 lds
    buffer_load_dwordx4 v7, s[8:11], s48 offen offset:3072 lds
    s_add_u32 m0, s18, 0
    s_add_u32 s48, s16, 0
    buffer_load_dwordx4 v248, s[12:15], s48 offen offset:0 lds
    buffer_load_dwordx4 v249, s[12:15], s48 offen offset:1024 lds
    s_add_u32 m0, s42, 8192
    s_add_u32 s48, s40, 128
    buffer_load_dwordx4 v4, s[8:11], s48 offen offset:0 lds
    buffer_load_dwordx4 v5, s[8:11], s48 offen offset:1024 lds
    buffer_load_dwordx4 v6, s[8:11], s48 offen offset:2048 lds
    buffer_load_dwordx4 v7, s[8:11], s48 offen offset:3072 lds
    s_add_u32 m0, s18, 24576
    s_add_u32 s48, s16, 3584
    buffer_load_dwordx4 v248, s[12:15], s48 offen offset:0 lds
    buffer_load_dwordx4 v249, s[12:15], s48 offen offset:1024 lds
    s_add_u32 m0, s42, 16384
    s_add_u32 s48, s40, 256
    buffer_load_dwordx4 v4, s[8:11], s48 offen offset:0 lds
    buffer_load_dwordx4 v5, s[8:11], s48 offen offset:1024 lds
    buffer_load_dwordx4 v6, s[8:11], s48 offen offset:2048 lds
    buffer_load_dwordx4 v7, s[8:11], s48 offen offset:3072 lds
    s_add_u32 m0, s18, 49152
    s_add_u32 s48, s16, 7168
    buffer_load_dwordx4 v248, s[12:15], s48 offen offset:0 lds
    buffer_load_dwordx4 v249, s[12:15], s48 offen offset:1024 lds
    s_add_u32 m0, s42, 24576
    s_add_u32 s48, s40, 384
    buffer_load_dwordx4 v4, s[8:11], s48 offen offset:0 lds
    buffer_load_dwordx4 v5, s[8:11], s48 offen offset:1024 lds
    buffer_load_dwordx4 v6, s[8:11], s48 offen offset:2048 lds
    buffer_load_dwordx4 v7, s[8:11], s48 offen offset:3072 lds
    s_add_u32 m0, s18, 73728
    s_add_u32 s48, s16, 10752
    buffer_load_dwordx4 v248, s[12:15], s48 offen offset:0 lds
    buffer_load_dwordx4 v249, s[12:15], s48 offen offset:1024 lds
    s_add_u32 m0, s42, 32768
    s_add_u32 s48, s40, 512
    buffer_load_dwordx4 v4, s[8:11], s48 offen offset:0 lds
    buffer_load_dwordx4 v5, s[8:11], s48 offen offset:1024 lds
    buffer_load_dwordx4 v6, s[8:11], s48 offen offset:2048 lds
    buffer_load_dwordx4 v7, s[8:11], s48 offen offset:3072 lds
    s_add_u32 m0, s18, 8192
    s_add_u32 s48, s16, 14336
    buffer_load_dwordx4 v248, s[12:15], s48 offen offset:0 lds
    buffer_load_dwordx4 v249, s[12:15], s48 offen offset:1024 lds
    s_add_u32 m0, s42, 40960
    s_add_u32 s48, s40, 640
    buffer_load_dwordx4 v4, s[8:11], s48 offen offset:0 lds
    buffer_load_dwordx4 v5, s[8:11], s48 offen offset:1024 lds
    buffer_load_dwordx4 v6, s[8:11], s48 offen offset:2048 lds
    buffer_load_dwordx4 v7, s[8:11], s48 offen offset:3072 lds
    s_add_u32 m0, s18, 32768
    s_add_u32 s48, s16, 17920
    buffer_load_dwordx4 v248, s[12:15], s48 offen offset:0 lds
    buffer_load_dwordx4 v249, s[12:15], s48 offen offset:1024 lds
    s_add_u32 m0, s42, 49152
    s_add_u32 s48, s40, 768
    buffer_load_dwordx4 v4, s[8:11], s48 offen offset:0 lds
    buffer_load_dwordx4 v5, s[8:11], s48 offen offset:1024 lds
    buffer_load_dwordx4 v6, s[8:11], s48 offen offset:2048 lds
    buffer_load_dwordx4 v7, s[8:11], s48 offen offset:3072 lds
    s_add_u32 m0, s18, 57344
    s_add_u32 s48, s16, 21504
    buffer_load_dwordx4 v248, s[12:15], s48 offen offset:0 lds
    buffer_load_dwordx4 v249, s[12:15], s48 offen offset:1024 lds
    s_mov_b32 s24, s98
    s_mov_b32 s25, s99
    s_mov_b32 s26, 0x6f0000
    s_mov_b32 s27, 0x20000
    s_mov_b32 s28, s96
    s_mov_b32 s29, s97
    s_mov_b32 s30, 0x100
    s_mov_b32 s31, 0x20000
    s_waitcnt vmcnt(36)
    s_barrier
    s_waitcnt vmcnt(30)
    s_barrier
    s_waitcnt vmcnt(24)
    s_barrier
    s_waitcnt vmcnt(18)
    s_barrier
    s_waitcnt vmcnt(12)
    s_barrier
    s_waitcnt vmcnt(6)
    s_barrier
    s_waitcnt vmcnt(0)
    s_cmp_eq_u32 s3, 1
    s_cbranch_scc0 L_nw7_6
    v_mov_b32 v12, 124
    s_mov_b32 s48, 0x100000
L_pn_7:
    buffer_load_dword v13, v12, s[28:31], 0 offen sc1
    s_waitcnt vmcnt(0)
    v_readfirstlane_b32 s6, v13
    s_sub_u32 s48, s48, 1
    s_cbranch_scc1 L_pnd_8
    s_cmp_eq_u32 s6, 0
    s_cbranch_scc1 L_pn_7
L_pnd_8:
    v_mov_b32 v12, 159232
    v_mov_b32 v13, s6
    ds_write_b32 v12, v13
    s_waitcnt lgkmcnt(0)
L_nw7_6:
    s_barrier
    s_barrier
    s_barrier
    s_mov_b32 s36, s72
    s_mov_b32 s37, s73
    s_mov_b32 s38, 0x62000
    s_mov_b32 s39, 0x20000
    s_lshr_b32 s48, s4, 1
    s_mul_i32 s48, s48, 28
    s_and_b32 s49, s4, 1
    s_lshl_b32 s49, s49, 4
    s_add_u32 s48, s48, s49
    s_lshl_b32 s49, s3, 3
    s_add_u32 s48, s48, s49
    s_mul_i32 s48, s48, 896
    s_mul_i32 s49, s3, 24576
    s_add_u32 s49, s49, 65536
    s_mov_b32 exec_hi, 0xffffff
    s_add_u32 m0, s49, 0
    s_add_u32 s50, s48, 0
    buffer_load_dwordx4 v2, s[36:39], s50 offen lds
    s_add_u32 m0, s49, 1024
    s_add_u32 s50, s48, 896
    buffer_load_dwordx4 v2, s[36:39], s50 offen lds
    s_add_u32 m0, s49, 2048
    s_add_u32 s50, s48, 1792
    buffer_load_dwordx4 v2, s[36:39], s50 offen lds
    s_add_u32 m0, s49, 3072
    s_add_u32 s50, s48, 2688
    buffer_load_dwordx4 v2, s[36:39], s50 offen lds
    s_add_u32 m0, s49, 4096
    s_add_u32 s50, s48, 3584
    buffer_load_dwordx4 v2, s[36:39], s50 offen lds
    s_add_u32 m0, s49, 5120
    s_add_u32 s50, s48, 4480
    buffer_load_dwordx4 v2, s[36:39], s50 offen lds
    s_add_u32 m0, s49, 6144
    s_add_u32 s50, s48, 5376
    buffer_load_dwordx4 v2, s[36:39], s50 offen lds
    s_add_u32 m0, s49, 7168
    s_add_u32 s50, s48, 6272
    buffer_load_dwordx4 v2, s[36:39], s50 offen lds
    s_mov_b64 exec, -1
    s_barrier
    s_barrier
    s_barrier
    s_barrier
    s_barrier
    s_branch L_aq
L7_w:
    s_add_u32 m0, s18, 0
    s_add_u32 s48, s16, 0
    buffer_load_dwordx4 v248, s[12:15], s48 offen offset:0 lds
    buffer_load_dwordx4 v249, s[12:15], s48 offen offset:1024 lds
    s_add_u32 m0, s18, 24576
    s_add_u32 s48, s16, 3584
    buffer_load_dwordx4 v248, s[12:15], s48 offen offset:0 lds
    buffer_load_dwordx4 v249, s[12:15], s48 offen offset:1024 lds
    s_add_u32 m0, s18, 49152
    s_add_u32 s48, s16, 7168
    buffer_load_dwordx4 v248, s[12:15], s48 offen offset:0 lds
    buffer_load_dwordx4 v249, s[12:15], s48 offen offset:1024 lds
    s_add_u32 m0, s18, 73728
    s_add_u32 s48, s16, 10752
    buffer_load_dwordx4 v248, s[12:15], s48 offen offset:0 lds
    buffer_load_dwordx4 v249, s[12:15], s48 offen offset:1024 lds
    s_add_u32 m0, s18, 8192
    s_add_u32 s48, s16, 14336
    buffer_load_dwordx4 v248, s[12:15], s48 offen offset:0 lds
    buffer_load_dwordx4 v249, s[12:15], s48 offen offset:1024 lds
    s_add_u32 m0, s18, 32768
    s_add_u32 s48, s16, 17920
    buffer_load_dwordx4 v248, s[12:15], s48 offen offset:0 lds
    buffer_load_dwordx4 v249, s[12:15], s48 offen offset:1024 lds
    s_add_u32 m0, s18, 57344
    s_add_u32 s48, s16, 21504
    buffer_load_dwordx4 v248, s[12:15], s48 offen offset:0 lds
    buffer_load_dwordx4 v249, s[12:15], s48 offen offset:1024 lds
    s_lshl_b32 s52, s22, 7
    buffer_load_ushort v240, v239, s[32:35], s52 offen
    s_add_u32 s52, s52, 128
    s_cmp_eq_u32 s52, 896
    s_cselect_b32 s52, 0, s52
    buffer_load_ushort v241, v239, s[32:35], s52 offen
    s_add_u32 s52, s52, 128
    s_cmp_eq_u32 s52, 896
    s_cselect_b32 s52, 0, s52
    buffer_load_ushort v242, v239, s[32:35], s52 offen
    s_add_u32 s52, s52, 128
    s_cmp_eq_u32 s52, 896
    s_cselect_b32 s52, 0, s52
    buffer_load_ushort v243, v239, s[32:35], s52 offen
    s_add_u32 s52, s52, 128
    s_cmp_eq_u32 s52, 896
    s_cselect_b32 s52, 0, s52
    buffer_load_ushort v244, v239, s[32:35], s52 offen
    s_add_u32 s52, s52, 128
    s_cmp_eq_u32 s52, 896
    s_cselect_b32 s52, 0, s52
    buffer_load_ushort v245, v239, s[32:35], s52 offen
    s_add_u32 s52, s52, 128
    s_cmp_eq_u32 s52, 896
    s_cselect_b32 s52, 0, s52
    buffer_load_ushort v246, v239, s[32:35], s52 offen
    s_add_u32 m0, s42, 0
    s_add_u32 s48, s40, 0
    s_mov_b64 exec, s[44:45]
    buffer_load_dwordx4 v4, s[8:11], s48 offen offset:0 lds
    buffer_load_dwordx4 v5, s[8:11], s48 offen offset:1024 lds
    buffer_load_dwordx4 v6, s[8:11], s48 offen offset:2048 lds
    buffer_load_dwordx4 v7, s[8:11], s48 offen offset:3072 lds
    s_mov_b64 exec, -1
    s_add_u32 m0, s42, 24576
    s_add_u32 s48, s40, 57344
    s_mov_b64 exec, s[44:45]
    buffer_load_dwordx4 v4, s[8:11], s48 offen offset:0 lds
    buffer_load_dwordx4 v5, s[8:11], s48 offen offset:1024 lds
    buffer_load_dwordx4 v6, s[8:11], s48 offen offset:2048 lds
    buffer_load_dwordx4 v7, s[8:11], s48 offen offset:3072 lds
    s_mov_b64 exec, -1
    s_add_u32 m0, s42, 49152
    s_add_u32 s48, s40, 114688
    s_mov_b64 exec, s[44:45]
    buffer_load_dwordx4 v4, s[8:11], s48 offen offset:0 lds
    buffer_load_dwordx4 v5, s[8:11], s48 offen offset:1024 lds
    buffer_load_dwordx4 v6, s[8:11], s48 offen offset:2048 lds
    buffer_load_dwordx4 v7, s[8:11], s48 offen offset:3072 lds
    s_mov_b64 exec, -1
    v_mul_u32_u24 v12, 896, v1
    s_and_b32 s48, s3, 1
    s_lshl_b32 s48, s48, 7
    s_add_u32 s48, s48, 192
    s_mul_i32 s48, s48, 896
    s_add_u32 s48, s48, 784
    buffer_load_dword v238, v12, s[8:11], s48 offen
    s_add_u32 s48, s48, 57344
    buffer_load_dword v238, v12, s[8:11], s48 offen
    s_mov_b32 s24, s98
    s_mov_b32 s25, s99
    s_mov_b32 s26, 0x6f0000
    s_mov_b32 s27, 0x20000
    s_mov_b32 s28, s96
    s_mov_b32 s29, s97
    s_mov_b32 s30, 0x100
    s_mov_b32 s31, 0x20000
    s_waitcnt vmcnt(33)
    s_barrier
    s_waitcnt vmcnt(31)
    s_barrier
    s_waitcnt vmcnt(29)
    s_barrier
    s_waitcnt vmcnt(27)
    s_barrier
    s_waitcnt vmcnt(25)
    s_barrier
    s_waitcnt vmcnt(23)
    s_barrier
    s_waitcnt vmcnt(21)
    s_barrier
    s_waitcnt vmcnt(10)
    v_add_u32 v11, 57344, v10
    s_mov_b64 exec, s[60:61]
    ds_write2_b32 v11, v240, v247 offset0:0 offset1:1
    s_mov_b64 exec, -1
    v_add_u32 v11, 81920, v10
    s_mov_b64 exec, s[60:61]
    ds_write2_b32 v11, v241, v247 offset0:0 offset1:1
    s_mov_b64 exec, -1
    v_add_u32 v11, 106496, v10
    s_mov_b64 exec, s[60:61]
    ds_write2_b32 v11, v242, v247 offset0:0 offset1:1
    s_mov_b64 exec, -1
    s_waitcnt lgkmcnt(0)
    s_barrier
    s_add_u32 m0, s42, 73728
    s_add_u32 s48, s40, 172032
    s_mov_b64 exec, s[44:45]
    buffer_load_dwordx4 v4, s[8:11], s48 offen offset:0 lds
    buffer_load_dwordx4 v5, s[8:11], s48 offen offset:1024 lds
    buffer_load_dwordx4 v6, s[8:11], s48 offen offset:2048 lds
    buffer_load_dwordx4 v7, s[8:11], s48 offen offset:3072 lds
    s_mov_b64 exec, -1
    v_add_u32 v11, 131072, v10
    s_mov_b64 exec, s[60:61]
    ds_write2_b32 v11, v243, v247 offset0:0 offset1:1
    s_mov_b64 exec, -1
    s_waitcnt vmcnt(10)
    s_waitcnt lgkmcnt(0)
    s_barrier
    s_add_u32 m0, s42, 0
    s_add_u32 s48, s40, 229376
    s_mov_b64 exec, s[44:45]
    buffer_load_dwordx4 v4, s[8:11], s48 offen offset:0 lds
    buffer_load_dwordx4 v5, s[8:11], s48 offen offset:1024 lds
    buffer_load_dwordx4 v6, s[8:11], s48 offen offset:2048 lds
    buffer_load_dwordx4 v7, s[8:11], s48 offen offset:3072 lds
    s_mov_b64 exec, -1
    v_add_u32 v11, 57344, v10
    s_mov_b64 exec, s[60:61]
    ds_write2_b32 v11, v244, v247 offset0:0 offset1:1
    s_mov_b64 exec, -1
    s_waitcnt vmcnt(10)
    s_waitcnt lgkmcnt(0)
    s_barrier
    s_add_u32 m0, s42, 24576
    s_add_u32 s48, s40, 286720
    s_mov_b64 exec, s[44:45]
    buffer_load_dwordx4 v4, s[8:11], s48 offen offset:0 lds
    buffer_load_dwordx4 v5, s[8:11], s48 offen offset:1024 lds
    buffer_load_dwordx4 v6, s[8:11], s48 offen offset:2048 lds
    buffer_load_dwordx4 v7, s[8:11], s48 offen offset:3072 lds
    s_mov_b64 exec, -1
    v_add_u32 v11, 81920, v10
    s_mov_b64 exec, s[60:61]
    ds_write2_b32 v11, v245, v247 offset0:0 offset1:1
    s_mov_b64 exec, -1
    s_waitcnt vmcnt(8)
    s_waitcnt lgkmcnt(0)
    s_barrier
    s_add_u32 m0, s42, 49152
    s_add_u32 s48, s40, 344064
    s_mov_b64 exec, s[44:45]
    buffer_load_dwordx4 v4, s[8:11], s48 offen offset:0 lds
    buffer_load_dwordx4 v5, s[8:11], s48 offen offset:1024 lds
    buffer_load_dwordx4 v6, s[8:11], s48 offen offset:2048 lds
    buffer_load_dwordx4 v7, s[8:11], s48 offen offset:3072 lds
    s_mov_b64 exec, -1
    v_add_u32 v11, 106496, v10
    s_mov_b64 exec, s[60:61]
    ds_write2_b32 v11, v246, v247 offset0:0 offset1:1
    s_mov_b64 exec, -1
    s_waitcnt vmcnt(8)
    s_waitcnt lgkmcnt(0)
    s_barrier
    s_waitcnt vmcnt(4)
    s_waitcnt lgkmcnt(0)
    s_barrier
    s_waitcnt vmcnt(0)
    s_waitcnt lgkmcnt(0)
    s_barrier
L_aq:
    v_lshrrev_b32 v11, 1, v1
    v_lshlrev_b32 v11, 7, v11
    v_and_b32 v12, 1, v1
    v_lshl_add_u32 v11, v12, 4, v11
    v_and_b32 v12, 31, v1
    v_bfe_u32 v13, v12, 2, 1
    v_lshlrev_b32 v13, 4, v13
    v_lshrrev_b32 v14, 3, v12
    v_lshl_add_u32 v13, v14, 2, v13
    v_and_b32 v14, 3, v12
    v_add_u32 v13, v13, v14
    s_lshr_b32 s48, s3, 1
    s_lshl_b32 s48, s48, 7
    s_add_u32 s48, s48, 155648
    v_lshlrev_b32 v13, 2, v13
    v_add_u32 v10, s48, v13
    v_mov_b32 v48, 0
    v_mov_b32 v49, 0
    v_mov_b32 v50, 0
    v_mov_b32 v51, 0
    v_mov_b32 v52, 0
    v_mov_b32 v53, 0
    v_mov_b32 v54, 0
    v_mov_b32 v55, 0
    v_mov_b32 v56, 0
    v_mov_b32 v57, 0
    v_mov_b32 v58, 0
    v_mov_b32 v59, 0
    v_mov_b32 v60, 0
    v_mov_b32 v61, 0
    v_mov_b32 v62, 0
    v_mov_b32 v63, 0
    v_mov_b32 v64, 0
    v_mov_b32 v65, 0
    v_mov_b32 v66, 0
    v_mov_b32 v67, 0
    v_mov_b32 v68, 0
    v_mov_b32 v69, 0
    v_mov_b32 v70, 0
    v_mov_b32 v71, 0
    v_mov_b32 v72, 0
    v_mov_b32 v73, 0
    v_mov_b32 v74, 0
    v_mov_b32 v75, 0
    v_mov_b32 v76, 0
    v_mov_b32 v77, 0
    v_mov_b32 v78, 0
    v_mov_b32 v79, 0
    v_mov_b32 v80, 0
    v_mov_b32 v81, 0
    v_mov_b32 v82, 0
    v_mov_b32 v83, 0
    v_mov_b32 v84, 0
    v_mov_b32 v85, 0
    v_mov_b32 v86, 0
    v_mov_b32 v87, 0
    v_mov_b32 v88, 0
    v_mov_b32 v89, 0
    v_mov_b32 v90, 0
    v_mov_b32 v91, 0
    v_mov_b32 v92, 0
    v_mov_b32 v93, 0
    v_mov_b32 v94, 0
    v_mov_b32 v95, 0
    v_mov_b32 v96, 0
    v_mov_b32 v97, 0
    v_mov_b32 v98, 0
    v_mov_b32 v99, 0
    v_mov_b32 v100, 0
    v_mov_b32 v101, 0
    v_mov_b32 v102, 0
    v_mov_b32 v103, 0
    v_mov_b32 v104, 0
    v_mov_b32 v105, 0
    v_mov_b32 v106, 0
    v_mov_b32 v107, 0
    v_mov_b32 v108, 0
    v_mov_b32 v109, 0
    v_mov_b32 v110, 0
    v_mov_b32 v111, 0
    s_mov_b32 s59, 0
    s_mov_b32 s58, 0
    s_mov_b32 s55, 0
    s_mov_b32 s54, 0
    s_mov_b32 s53, 0
    s_mov_b32 s57, 0
    s_and_b32 s50, s2, 7
    s_lshl_b32 s50, s50, 12
    s_add_u32 s50, s50, 540672
    s_cmp_eq_u32 s3, 0
    s_cbranch_scc0 L_kve_9
    buffer_load_dwordx4 v[4:7], v11, s[24:27], s50 offen sc1
L_kve_9:
    s_mov_b32 s53, 0
    v_mov_b32 v14, 159232
    s_barrier
    ds_read_b32 v13, v14
    s_xor_b32 s48, s3, 1
    s_lshl_b32 s48, s48, 11
    s_add_u32 s48, s48, 57344
    v_add_u32 v12, s48, v2
    ds_read_b128 v[16:19], v12
    ds_read_b128 v[20:23], v12 offset:1024
    s_xor_b32 s48, s3, 2
    s_lshl_b32 s48, s48, 11
    s_add_u32 s48, s48, 57344
    v_add_u32 v12, s48, v2
    ds_read_b128 v[24:27], v12
    ds_read_b128 v[28:31], v12 offset:1024
    s_xor_b32 s48, s3, 3
    s_lshl_b32 s48, s48, 11
    s_add_u32 s48, s48, 57344
    v_add_u32 v12, s48, v2
    ds_read_b128 v[32:35], v12
    ds_read_b128 v[36:39], v12 offset:1024
    s_xor_b32 s48, s3, 0
    s_lshl_b32 s48, s48, 11
    s_add_u32 s48, s48, 57344
    v_add_u32 v12, s48, v2
    ds_read_b128 v[40:43], v12
    ds_read_b128 v[44:47], v12 offset:1024
    ds_read_b32 v10, v10
    s_setprio 3
    s_waitcnt lgkmcnt(9)
    v_readfirstlane_b32 s6, v13
    s_cmp_eq_u32 s3, 0
    s_cbranch_scc0 L_kvw_10
    s_cmp_lg_u32 s57, 0
    s_cbranch_scc1 L_kvb_11
    s_mov_b32 s48, 0x100000
L_pkv_12:
    s_waitcnt vmcnt(0)
    v_xor_b32 v12, s6, v7
    v_xor_b32 v13, s6, v5
    v_or_b32 v12, v12, v13
    v_cmp_ne_u32 vcc, 0, v12
    s_sub_u32 s48, s48, 1
    s_cbranch_scc1 L_pkvd_13
    s_nop 2
    s_cbranch_vccz L_pkvd_13
    buffer_load_dwordx4 v[4:7], v11, s[24:27], s50 offen sc1
    s_branch L_pkv_12
L_pkvd_13:
    v_max_f32 v13, v6, v4
    s_nop 1
    v_max_f32_dpp v13, v13, v13 row_shr:1 row_mask:0xf bank_mask:0xf
    s_nop 1
    v_max_f32_dpp v13, v13, v13 row_shr:2 row_mask:0xf bank_mask:0xf
    s_nop 1
    v_max_f32_dpp v13, v13, v13 row_shr:4 row_mask:0xf bank_mask:0xf
    s_nop 1
    v_max_f32_dpp v13, v13, v13 row_shr:8 row_mask:0xf bank_mask:0xf
    s_nop 1
    v_readlane_b32 s48, v13, 15
    v_readlane_b32 s49, v13, 31
    v_readlane_b32 s51, v13, 47
    v_readlane_b32 s52, v13, 63
    s_nop 3
    s_max_u32 s48, s48, s51
    s_max_u32 s49, s49, s52
    s_max_u32 s48, s48, s49
    s_or_b32 s57, s48, 1
    v_mov_b32 v14, s57
    v_mov_b32 v12, 159872
    ds_write_b32 v12, v14
    s_branch L_kvb_11
L_kvw_10:
    s_waitcnt vmcnt(0)
    v_mov_b32 v12, 159872
    s_mov_b32 s49, 0x400000
L_kvs_14:
    ds_read_b32 v14, v12
    s_waitcnt lgkmcnt(0)
    v_readfirstlane_b32 s57, v14
    s_sub_u32 s49, s49, 1
    s_cbranch_scc1 L_kvsd_15
    s_cmp_eq_u32 s57, 0
    s_cbranch_scc1 L_kvs_14
L_kvsd_15:
L_kvb_11:
    s_setprio 1
L_attn_entry:
    s_lshl_b32 s60, s3, 16
    s_add_u32 s60, s60, 0
    v_mov_b32 v8, 159772
    v_mov_b32 v9, 1
    v_mov_b32 v15, 0
    buffer_load_dwordx4 v[160:163], v2, s[24:27], s60 offen offset:0 sc1
    buffer_load_dwordx4 v[164:167], v2, s[24:27], s60 offen offset:1024 sc1
    buffer_load_dwordx4 v[168:171], v2, s[24:27], s60 offen offset:2048 sc1
    buffer_load_dwordx4 v[172:175], v2, s[24:27], s60 offen offset:3072 sc1
    s_add_u32 s60, s60, 4096
    buffer_load_dwordx4 v[176:179], v2, s[24:27], s60 offen offset:0 sc1
    buffer_load_dwordx4 v[180:183], v2, s[24:27], s60 offen offset:1024 sc1
    buffer_load_dwordx4 v[184:187], v2, s[24:27], s60 offen offset:2048 sc1
    buffer_load_dwordx4 v[188:191], v2, s[24:27], s60 offen offset:3072 sc1
    s_add_u32 s60, s60, 4096
    buffer_load_dwordx4 v[192:195], v2, s[24:27], s60 offen offset:0 sc1
    buffer_load_dwordx4 v[196:199], v2, s[24:27], s60 offen offset:1024 sc1
    buffer_load_dwordx4 v[200:203], v2, s[24:27], s60 offen offset:2048 sc1
    buffer_load_dwordx4 v[204:207], v2, s[24:27], s60 offen offset:3072 sc1
    s_add_u32 s60, s60, 4096
    s_or_b32 s48, s59, s53
    s_cmp_eq_u32 s48, 0
    s_cbranch_scc0 L_pt_16
    s_waitcnt lgkmcnt(0)
    v_mov_b32 v12, 159784
    v_mov_b32 v13, 1
    s_mov_b64 exec, 1
    ds_add_u32 v12, v13
    s_mov_b64 exec, -1
    s_cmp_eq_u32 s5, 7
    s_cbranch_scc0 L_wrs_17
    s_cmp_lt_u32 s3, 2
    s_cbranch_scc0 L_wrs_17
    v_mov_b32 v12, 159800
    v_mov_b32 v13, 1
    s_mov_b64 exec, 1
    ds_add_u32 v12, v13
    s_mov_b64 exec, -1
L_wrs_17:
    v_mov_b32 v13, s57
    v_sqrt_f32 v13, v13
    s_mov_b32 s49, 0xbf820000
    s_nop 0
    v_mul_f32 v13, s49, v13
    v_lshlrev_b32 v12, 16, v22
    v_mul_f32 v12, v12, v13
    v_cvt_pk_bf16_f32 v12, v12, v247
    v_cndmask_b32 v22, v22, v12, s[46:47]
    v_lshlrev_b32 v12, 16, v30
    v_mul_f32 v12, v12, v13
    v_cvt_pk_bf16_f32 v12, v12, v247
    v_cndmask_b32 v30, v30, v12, s[46:47]
    v_lshlrev_b32 v12, 16, v38
    v_mul_f32 v12, v12, v13
    v_cvt_pk_bf16_f32 v12, v12, v247
    v_cndmask_b32 v38, v38, v12, s[46:47]
    v_lshlrev_b32 v12, 16, v46
    v_mul_f32 v12, v12, v13
    v_cvt_pk_bf16_f32 v12, v12, v247
    v_cndmask_b32 v46, v46, v12, s[46:47]
L_pt_16:
    s_waitcnt vmcnt(8)
    v_mfma_f32_32x32x16_bf16 v[112:127], v[160:163], v[16:19], 0
    v_mfma_f32_32x32x16_bf16 v[112:127], v[164:167], v[20:23], v[112:127]
    s_nop 7
    s_nop 7
    v_mfma_f32_32x32x16_bf16 v[128:143], v[160:163], v[24:27], 0
    v_exp_f32 v112, v112
    v_exp_f32 v113, v113
    v_exp_f32 v114, v114
    v_exp_f32 v115, v115
    v_cvt_pk_bf16_f32 v144, v112, v113
    v_cvt_pk_bf16_f32 v145, v114, v115
    v_mfma_f32_32x32x16_bf16 v[128:143], v[164:167], v[28:31], v[128:143]
    v_exp_f32 v116, v116
    v_exp_f32 v117, v117
    v_exp_f32 v118, v118
    v_exp_f32 v119, v119
    v_cvt_pk_bf16_f32 v146, v116, v117
    v_cvt_pk_bf16_f32 v147, v118, v119
    v_exp_f32 v120, v120
    v_exp_f32 v121, v121
    v_exp_f32 v122, v122
    v_exp_f32 v123, v123
    v_cvt_pk_bf16_f32 v148, v120, v121
    v_cvt_pk_bf16_f32 v149, v122, v123
    v_exp_f32 v124, v124
    v_exp_f32 v125, v125
    v_exp_f32 v126, v126
    v_exp_f32 v127, v127
    v_cvt_pk_bf16_f32 v150, v124, v125
    v_cvt_pk_bf16_f32 v151, v126, v127
    s_mov_b32 s61, 3
.p2align 6
L_attn_18:
    v_mfma_f32_32x32x16_bf16 v[112:127], v[160:163], v[32:35], 0
    buffer_load_dwordx4 v[208:211], v2, s[24:27], s60 offen offset:0 sc1
    v_exp_f32 v128, v128
    v_exp_f32 v129, v129
    v_exp_f32 v130, v130
    v_exp_f32 v131, v131
    v_cvt_pk_bf16_f32 v152, v128, v129
    v_cvt_pk_bf16_f32 v153, v130, v131
    v_mfma_f32_32x32x16_bf16 v[112:127], v[164:167], v[36:39], v[112:127]
    v_exp_f32 v132, v132
    v_exp_f32 v133, v133
    v_exp_f32 v134, v134
    v_exp_f32 v135, v135
    v_cvt_pk_bf16_f32 v154, v132, v133
    v_cvt_pk_bf16_f32 v155, v134, v135
    v_mfma_f32_32x32x16_bf16 v[48:63], v[168:171], v[144:147], v[48:63]
    v_exp_f32 v136, v136
    v_exp_f32 v137, v137
    v_exp_f32 v138, v138
    v_exp_f32 v139, v139
    v_cvt_pk_bf16_f32 v156, v136, v137
    v_cvt_pk_bf16_f32 v157, v138, v139
    v_mfma_f32_32x32x16_bf16 v[48:63], v[172:175], v[148:151], v[48:63]
    v_exp_f32 v140, v140
    v_exp_f32 v141, v141
    v_exp_f32 v142, v142
    v_exp_f32 v143, v143
    v_cvt_pk_bf16_f32 v158, v140, v141
    v_cvt_pk_bf16_f32 v159, v142, v143
    v_mfma_f32_32x32x16_bf16 v[128:143], v[160:163], v[40:43], 0
    buffer_load_dwordx4 v[212:215], v2, s[24:27], s60 offen offset:1024 sc1
    v_exp_f32 v112, v112
    v_exp_f32 v113, v113
    v_exp_f32 v114, v114
    v_exp_f32 v115, v115
    v_cvt_pk_bf16_f32 v144, v112, v113
    v_cvt_pk_bf16_f32 v145, v114, v115
    v_mfma_f32_32x32x16_bf16 v[128:143], v[164:167], v[44:47], v[128:143]
    v_exp_f32 v116, v116
    v_exp_f32 v117, v117
    v_exp_f32 v118, v118
    v_exp_f32 v119, v119
    v_cvt_pk_bf16_f32 v146, v116, v117
    v_cvt_pk_bf16_f32 v147, v118, v119
    v_mfma_f32_32x32x16_bf16 v[64:79], v[168:171], v[152:155], v[64:79]
    v_exp_f32 v120, v120
    v_exp_f32 v121, v121
    v_exp_f32 v122, v122
    v_exp_f32 v123, v123
    v_cvt_pk_bf16_f32 v148, v120, v121
    v_cvt_pk_bf16_f32 v149, v122, v123
    v_mfma_f32_32x32x16_bf16 v[64:79], v[172:175], v[156:159], v[64:79]
    s_waitcnt vmcnt(6)
    v_exp_f32 v124, v124
    v_exp_f32 v125, v125
    v_exp_f32 v126, v126
    v_exp_f32 v127, v127
    v_cvt_pk_bf16_f32 v150, v124, v125
    v_cvt_pk_bf16_f32 v151, v126, v127
    v_mfma_f32_32x32x16_bf16 v[112:127], v[176:179], v[16:19], 0
    buffer_load_dwordx4 v[216:219], v2, s[24:27], s60 offen offset:2048 sc1
    v_exp_f32 v128, v128
    v_exp_f32 v129, v129
    v_exp_f32 v130, v130
    v_exp_f32 v131, v131
    v_cvt_pk_bf16_f32 v152, v128, v129
    v_cvt_pk_bf16_f32 v153, v130, v131
    v_mfma_f32_32x32x16_bf16 v[112:127], v[180:183], v[20:23], v[112:127]
    v_exp_f32 v132, v132
    v_exp_f32 v133, v133
    v_exp_f32 v134, v134
    v_exp_f32 v135, v135
    v_cvt_pk_bf16_f32 v154, v132, v133
    v_cvt_pk_bf16_f32 v155, v134, v135
    v_mfma_f32_32x32x16_bf16 v[80:95], v[168:171], v[144:147], v[80:95]
    v_exp_f32 v136, v136
    v_exp_f32 v137, v137
    v_exp_f32 v138, v138
    v_exp_f32 v139, v139
    v_cvt_pk_bf16_f32 v156, v136, v137
    v_cvt_pk_bf16_f32 v157, v138, v139
    v_mfma_f32_32x32x16_bf16 v[80:95], v[172:175], v[148:151], v[80:95]
    v_exp_f32 v140, v140
    v_exp_f32 v141, v141
    v_exp_f32 v142, v142
    v_exp_f32 v143, v143
    v_cvt_pk_bf16_f32 v158, v140, v141
    v_cvt_pk_bf16_f32 v159, v142, v143
    v_mfma_f32_32x32x16_bf16 v[128:143], v[176:179], v[24:27], 0
    buffer_load_dwordx4 v[220:223], v2, s[24:27], s60 offen offset:3072 sc1
    v_exp_f32 v112, v112
    v_exp_f32 v113, v113
    v_exp_f32 v114, v114
    v_exp_f32 v115, v115
    v_cvt_pk_bf16_f32 v144, v112, v113
    v_cvt_pk_bf16_f32 v145, v114, v115
    v_mfma_f32_32x32x16_bf16 v[128:143], v[180:183], v[28:31], v[128:143]
    s_add_u32 s60, s60, 4096
    v_exp_f32 v116, v116
    v_exp_f32 v117, v117
    v_exp_f32 v118, v118
    v_exp_f32 v119, v119
    v_cvt_pk_bf16_f32 v146, v116, v117
    v_cvt_pk_bf16_f32 v147, v118, v119
    v_mfma_f32_32x32x16_bf16 v[96:111], v[168:171], v[152:155], v[96:111]
    v_exp_f32 v120, v120
    v_exp_f32 v121, v121
    v_exp_f32 v122, v122
    v_exp_f32 v123, v123
    v_cvt_pk_bf16_f32 v148, v120, v121
    v_cvt_pk_bf16_f32 v149, v122, v123
    v_mfma_f32_32x32x16_bf16 v[96:111], v[172:175], v[156:159], v[96:111]
    v_exp_f32 v124, v124
    v_exp_f32 v125, v125
    v_exp_f32 v126, v126
    v_exp_f32 v127, v127
    v_cvt_pk_bf16_f32 v150, v124, v125
    v_cvt_pk_bf16_f32 v151, v126, v127
    v_mfma_f32_32x32x16_bf16 v[112:127], v[176:179], v[32:35], 0
    buffer_load_dwordx4 v[160:163], v2, s[24:27], s60 offen offset:0 sc1
    v_exp_f32 v128, v128
    v_exp_f32 v129, v129
    v_exp_f32 v130, v130
    v_exp_f32 v131, v131
    v_cvt_pk_bf16_f32 v152, v128, v129
    v_cvt_pk_bf16_f32 v153, v130, v131
    v_mfma_f32_32x32x16_bf16 v[112:127], v[180:183], v[36:39], v[112:127]
    v_exp_f32 v132, v132
    v_exp_f32 v133, v133
    v_exp_f32 v134, v134
    v_exp_f32 v135, v135
    v_cvt_pk_bf16_f32 v154, v132, v133
    v_cvt_pk_bf16_f32 v155, v134, v135
    v_mfma_f32_32x32x16_bf16 v[48:63], v[184:187], v[144:147], v[48:63]
    v_exp_f32 v136, v136
    v_exp_f32 v137, v137
    v_exp_f32 v138, v138
    v_exp_f32 v139, v139
    v_cvt_pk_bf16_f32 v156, v136, v137
    v_cvt_pk_bf16_f32 v157, v138, v139
    v_mfma_f32_32x32x16_bf16 v[48:63], v[188:191], v[148:151], v[48:63]
    v_exp_f32 v140, v140
    v_exp_f32 v141, v141
    v_exp_f32 v142, v142
    v_exp_f32 v143, v143
    v_cvt_pk_bf16_f32 v158, v140, v141
    v_cvt_pk_bf16_f32 v159, v142, v143
    v_mfma_f32_32x32x16_bf16 v[128:143], v[176:179], v[40:43], 0
    buffer_load_dwordx4 v[164:167], v2, s[24:27], s60 offen offset:1024 sc1
    v_exp_f32 v112, v112
    v_exp_f32 v113, v113
    v_exp_f32 v114, v114
    v_exp_f32 v115, v115
    v_cvt_pk_bf16_f32 v144, v112, v113
    v_cvt_pk_bf16_f32 v145, v114, v115
    v_mfma_f32_32x32x16_bf16 v[128:143], v[180:183], v[44:47], v[128:143]
    v_exp_f32 v116, v116
    v_exp_f32 v117, v117
    v_exp_f32 v118, v118
    v_exp_f32 v119, v119
    v_cvt_pk_bf16_f32 v146, v116, v117
    v_cvt_pk_bf16_f32 v147, v118, v119
    v_mfma_f32_32x32x16_bf16 v[64:79], v[184:187], v[152:155], v[64:79]
    v_exp_f32 v120, v120
    v_exp_f32 v121, v121
    v_exp_f32 v122, v122
    v_exp_f32 v123, v123
    v_cvt_pk_bf16_f32 v148, v120, v121
    v_cvt_pk_bf16_f32 v149, v122, v123
    v_mfma_f32_32x32x16_bf16 v[64:79], v[188:191], v[156:159], v[64:79]
    s_waitcnt vmcnt(6)
    v_exp_f32 v124, v124
    v_exp_f32 v125, v125
    v_exp_f32 v126, v126
    v_exp_f32 v127, v127
    v_cvt_pk_bf16_f32 v150, v124, v125
    v_cvt_pk_bf16_f32 v151, v126, v127
    v_mfma_f32_32x32x16_bf16 v[112:127], v[192:195], v[16:19], 0
    buffer_load_dwordx4 v[168:171], v2, s[24:27], s60 offen offset:2048 sc1
    v_exp_f32 v128, v128
    v_exp_f32 v129, v129
    v_exp_f32 v130, v130
    v_exp_f32 v131, v131
    v_cvt_pk_bf16_f32 v152, v128, v129
    v_cvt_pk_bf16_f32 v153, v130, v131
    v_mfma_f32_32x32x16_bf16 v[112:127], v[196:199], v[20:23], v[112:127]
    v_exp_f32 v132, v132
    v_exp_f32 v133, v133
    v_exp_f32 v134, v134
    v_exp_f32 v135, v135
    v_cvt_pk_bf16_f32 v154, v132, v133
    v_cvt_pk_bf16_f32 v155, v134, v135
    v_mfma_f32_32x32x16_bf16 v[80:95], v[184:187], v[144:147], v[80:95]
    v_exp_f32 v136, v136
    v_exp_f32 v137, v137
    v_exp_f32 v138, v138
    v_exp_f32 v139, v139
    v_cvt_pk_bf16_f32 v156, v136, v137
    v_cvt_pk_bf16_f32 v157, v138, v139
    v_mfma_f32_32x32x16_bf16 v[80:95], v[188:191], v[148:151], v[80:95]
    v_exp_f32 v140, v140
    v_exp_f32 v141, v141
    v_exp_f32 v142, v142
    v_exp_f32 v143, v143
    v_cvt_pk_bf16_f32 v158, v140, v141
    v_cvt_pk_bf16_f32 v159, v142, v143
    v_mfma_f32_32x32x16_bf16 v[128:143], v[192:195], v[24:27], 0
    buffer_load_dwordx4 v[172:175], v2, s[24:27], s60 offen offset:3072 sc1
    v_exp_f32 v112, v112
    v_exp_f32 v113, v113
    v_exp_f32 v114, v114
    v_exp_f32 v115, v115
    v_cvt_pk_bf16_f32 v144, v112, v113
    v_cvt_pk_bf16_f32 v145, v114, v115
    v_mfma_f32_32x32x16_bf16 v[128:143], v[196:199], v[28:31], v[128:143]
    s_add_u32 s60, s60, 4096
    v_exp_f32 v116, v116
    v_exp_f32 v117, v117
    v_exp_f32 v118, v118
    v_exp_f32 v119, v119
    v_cvt_pk_bf16_f32 v146, v116, v117
    v_cvt_pk_bf16_f32 v147, v118, v119
    v_mfma_f32_32x32x16_bf16 v[96:111], v[184:187], v[152:155], v[96:111]
    v_exp_f32 v120, v120
    v_exp_f32 v121, v121
    v_exp_f32 v122, v122
    v_exp_f32 v123, v123
    v_cvt_pk_bf16_f32 v148, v120, v121
    v_cvt_pk_bf16_f32 v149, v122, v123
    v_mfma_f32_32x32x16_bf16 v[96:111], v[188:191], v[156:159], v[96:111]
    v_exp_f32 v124, v124
    v_exp_f32 v125, v125
    v_exp_f32 v126, v126
    v_exp_f32 v127, v127
    v_cvt_pk_bf16_f32 v150, v124, v125
    v_cvt_pk_bf16_f32 v151, v126, v127
    v_mfma_f32_32x32x16_bf16 v[112:127], v[192:195], v[32:35], 0
    buffer_load_dwordx4 v[176:179], v2, s[24:27], s60 offen offset:0 sc1
    v_exp_f32 v128, v128
    v_exp_f32 v129, v129
    v_exp_f32 v130, v130
    v_exp_f32 v131, v131
    v_cvt_pk_bf16_f32 v152, v128, v129
    v_cvt_pk_bf16_f32 v153, v130, v131
    v_mfma_f32_32x32x16_bf16 v[112:127], v[196:199], v[36:39], v[112:127]
    v_exp_f32 v132, v132
    v_exp_f32 v133, v133
    v_exp_f32 v134, v134
    v_exp_f32 v135, v135
    v_cvt_pk_bf16_f32 v154, v132, v133
    v_cvt_pk_bf16_f32 v155, v134, v135
    v_mfma_f32_32x32x16_bf16 v[48:63], v[200:203], v[144:147], v[48:63]
    v_exp_f32 v136, v136
    v_exp_f32 v137, v137
    v_exp_f32 v138, v138
    v_exp_f32 v139, v139
    v_cvt_pk_bf16_f32 v156, v136, v137
    v_cvt_pk_bf16_f32 v157, v138, v139
    v_mfma_f32_32x32x16_bf16 v[48:63], v[204:207], v[148:151], v[48:63]
    v_exp_f32 v140, v140
    v_exp_f32 v141, v141
    v_exp_f32 v142, v142
    v_exp_f32 v143, v143
    v_cvt_pk_bf16_f32 v158, v140, v141
    v_cvt_pk_bf16_f32 v159, v142, v143
    v_mfma_f32_32x32x16_bf16 v[128:143], v[192:195], v[40:43], 0
    buffer_load_dwordx4 v[180:183], v2, s[24:27], s60 offen offset:1024 sc1
    v_exp_f32 v112, v112
    v_exp_f32 v113, v113
    v_exp_f32 v114, v114
    v_exp_f32 v115, v115
    v_cvt_pk_bf16_f32 v144, v112, v113
    v_cvt_pk_bf16_f32 v145, v114, v115
    v_mfma_f32_32x32x16_bf16 v[128:143], v[196:199], v[44:47], v[128:143]
    v_exp_f32 v116, v116
    v_exp_f32 v117, v117
    v_exp_f32 v118, v118
    v_exp_f32 v119, v119
    v_cvt_pk_bf16_f32 v146, v116, v117
    v_cvt_pk_bf16_f32 v147, v118, v119
    v_mfma_f32_32x32x16_bf16 v[64:79], v[200:203], v[152:155], v[64:79]
    v_exp_f32 v120, v120
    v_exp_f32 v121, v121
    v_exp_f32 v122, v122
    v_exp_f32 v123, v123
    v_cvt_pk_bf16_f32 v148, v120, v121
    v_cvt_pk_bf16_f32 v149, v122, v123
    v_mfma_f32_32x32x16_bf16 v[64:79], v[204:207], v[156:159], v[64:79]
    s_waitcnt vmcnt(6)
    v_exp_f32 v124, v124
    v_exp_f32 v125, v125
    v_exp_f32 v126, v126
    v_exp_f32 v127, v127
    v_cvt_pk_bf16_f32 v150, v124, v125
    v_cvt_pk_bf16_f32 v151, v126, v127
    v_mfma_f32_32x32x16_bf16 v[112:127], v[208:211], v[16:19], 0
    buffer_load_dwordx4 v[184:187], v2, s[24:27], s60 offen offset:2048 sc1
    v_exp_f32 v128, v128
    v_exp_f32 v129, v129
    v_exp_f32 v130, v130
    v_exp_f32 v131, v131
    v_cvt_pk_bf16_f32 v152, v128, v129
    v_cvt_pk_bf16_f32 v153, v130, v131
    v_mfma_f32_32x32x16_bf16 v[112:127], v[212:215], v[20:23], v[112:127]
    v_exp_f32 v132, v132
    v_exp_f32 v133, v133
    v_exp_f32 v134, v134
    v_exp_f32 v135, v135
    v_cvt_pk_bf16_f32 v154, v132, v133
    v_cvt_pk_bf16_f32 v155, v134, v135
    v_mfma_f32_32x32x16_bf16 v[80:95], v[200:203], v[144:147], v[80:95]
    v_exp_f32 v136, v136
    v_exp_f32 v137, v137
    v_exp_f32 v138, v138
    v_exp_f32 v139, v139
    v_cvt_pk_bf16_f32 v156, v136, v137
    v_cvt_pk_bf16_f32 v157, v138, v139
    v_mfma_f32_32x32x16_bf16 v[80:95], v[204:207], v[148:151], v[80:95]
    v_exp_f32 v140, v140
    v_exp_f32 v141, v141
    v_exp_f32 v142, v142
    v_exp_f32 v143, v143
    v_cvt_pk_bf16_f32 v158, v140, v141
    v_cvt_pk_bf16_f32 v159, v142, v143
    v_mfma_f32_32x32x16_bf16 v[128:143], v[208:211], v[24:27], 0
    buffer_load_dwordx4 v[188:191], v2, s[24:27], s60 offen offset:3072 sc1
    v_exp_f32 v112, v112
    v_exp_f32 v113, v113
    v_exp_f32 v114, v114
    v_exp_f32 v115, v115
    v_cvt_pk_bf16_f32 v144, v112, v113
    v_cvt_pk_bf16_f32 v145, v114, v115
    v_mfma_f32_32x32x16_bf16 v[128:143], v[212:215], v[28:31], v[128:143]
    s_add_u32 s60, s60, 4096
    v_exp_f32 v116, v116
    v_exp_f32 v117, v117
    v_exp_f32 v118, v118
    v_exp_f32 v119, v119
    v_cvt_pk_bf16_f32 v146, v116, v117
    v_cvt_pk_bf16_f32 v147, v118, v119
    v_mfma_f32_32x32x16_bf16 v[96:111], v[200:203], v[152:155], v[96:111]
    v_exp_f32 v120, v120
    v_exp_f32 v121, v121
    v_exp_f32 v122, v122
    v_exp_f32 v123, v123
    v_cvt_pk_bf16_f32 v148, v120, v121
    v_cvt_pk_bf16_f32 v149, v122, v123
    v_mfma_f32_32x32x16_bf16 v[96:111], v[204:207], v[156:159], v[96:111]
    v_exp_f32 v124, v124
    v_exp_f32 v125, v125
    v_exp_f32 v126, v126
    v_exp_f32 v127, v127
    v_cvt_pk_bf16_f32 v150, v124, v125
    v_cvt_pk_bf16_f32 v151, v126, v127
    v_mfma_f32_32x32x16_bf16 v[112:127], v[208:211], v[32:35], 0
    buffer_load_dwordx4 v[192:195], v2, s[24:27], s60 offen offset:0 sc1
    v_exp_f32 v128, v128
    v_exp_f32 v129, v129
    v_exp_f32 v130, v130
    v_exp_f32 v131, v131
    v_cvt_pk_bf16_f32 v152, v128, v129
    v_cvt_pk_bf16_f32 v153, v130, v131
    v_mfma_f32_32x32x16_bf16 v[112:127], v[212:215], v[36:39], v[112:127]
    v_exp_f32 v132, v132
    v_exp_f32 v133, v133
    v_exp_f32 v134, v134
    v_exp_f32 v135, v135
    v_cvt_pk_bf16_f32 v154, v132, v133
    v_cvt_pk_bf16_f32 v155, v134, v135
    v_mfma_f32_32x32x16_bf16 v[48:63], v[216:219], v[144:147], v[48:63]
    v_exp_f32 v136, v136
    v_exp_f32 v137, v137
    v_exp_f32 v138, v138
    v_exp_f32 v139, v139
    v_cvt_pk_bf16_f32 v156, v136, v137
    v_cvt_pk_bf16_f32 v157, v138, v139
    v_mfma_f32_32x32x16_bf16 v[48:63], v[220:223], v[148:151], v[48:63]
    v_exp_f32 v140, v140
    v_exp_f32 v141, v141
    v_exp_f32 v142, v142
    v_exp_f32 v143, v143
    v_cvt_pk_bf16_f32 v158, v140, v141
    v_cvt_pk_bf16_f32 v159, v142, v143
    v_mfma_f32_32x32x16_bf16 v[128:143], v[208:211], v[40:43], 0
    buffer_load_dwordx4 v[196:199], v2, s[24:27], s60 offen offset:1024 sc1
    v_exp_f32 v112, v112
    v_exp_f32 v113, v113
    v_exp_f32 v114, v114
    v_exp_f32 v115, v115
    v_cvt_pk_bf16_f32 v144, v112, v113
    v_cvt_pk_bf16_f32 v145, v114, v115
    v_mfma_f32_32x32x16_bf16 v[128:143], v[212:215], v[44:47], v[128:143]
    v_exp_f32 v116, v116
    v_exp_f32 v117, v117
    v_exp_f32 v118, v118
    v_exp_f32 v119, v119
    v_cvt_pk_bf16_f32 v146, v116, v117
    v_cvt_pk_bf16_f32 v147, v118, v119
    v_mfma_f32_32x32x16_bf16 v[64:79], v[216:219], v[152:155], v[64:79]
    v_exp_f32 v120, v120
    v_exp_f32 v121, v121
    v_exp_f32 v122, v122
    v_exp_f32 v123, v123
    v_cvt_pk_bf16_f32 v148, v120, v121
    v_cvt_pk_bf16_f32 v149, v122, v123
    v_mfma_f32_32x32x16_bf16 v[64:79], v[220:223], v[156:159], v[64:79]
    s_waitcnt vmcnt(6)
    v_exp_f32 v124, v124
    v_exp_f32 v125, v125
    v_exp_f32 v126, v126
    v_exp_f32 v127, v127
    v_cvt_pk_bf16_f32 v150, v124, v125
    v_cvt_pk_bf16_f32 v151, v126, v127
    v_mfma_f32_32x32x16_bf16 v[112:127], v[160:163], v[16:19], 0
    buffer_load_dwordx4 v[200:203], v2, s[24:27], s60 offen offset:2048 sc1
    v_exp_f32 v128, v128
    v_exp_f32 v129, v129
    v_exp_f32 v130, v130
    v_exp_f32 v131, v131
    v_cvt_pk_bf16_f32 v152, v128, v129
    v_cvt_pk_bf16_f32 v153, v130, v131
    v_mfma_f32_32x32x16_bf16 v[112:127], v[164:167], v[20:23], v[112:127]
    v_exp_f32 v132, v132
    v_exp_f32 v133, v133
    v_exp_f32 v134, v134
    v_exp_f32 v135, v135
    v_cvt_pk_bf16_f32 v154, v132, v133
    v_cvt_pk_bf16_f32 v155, v134, v135
    v_mfma_f32_32x32x16_bf16 v[80:95], v[216:219], v[144:147], v[80:95]
    v_exp_f32 v136, v136
    v_exp_f32 v137, v137
    v_exp_f32 v138, v138
    v_exp_f32 v139, v139
    v_cvt_pk_bf16_f32 v156, v136, v137
    v_cvt_pk_bf16_f32 v157, v138, v139
    v_mfma_f32_32x32x16_bf16 v[80:95], v[220:223], v[148:151], v[80:95]
    v_exp_f32 v140, v140
    v_exp_f32 v141, v141
    v_exp_f32 v142, v142
    v_exp_f32 v143, v143
    v_cvt_pk_bf16_f32 v158, v140, v141
    v_cvt_pk_bf16_f32 v159, v142, v143
    v_mfma_f32_32x32x16_bf16 v[128:143], v[160:163], v[24:27], 0
    buffer_load_dwordx4 v[204:207], v2, s[24:27], s60 offen offset:3072 sc1
    v_exp_f32 v112, v112
    v_exp_f32 v113, v113
    v_exp_f32 v114, v114
    v_exp_f32 v115, v115
    v_cvt_pk_bf16_f32 v144, v112, v113
    v_cvt_pk_bf16_f32 v145, v114, v115
    v_mfma_f32_32x32x16_bf16 v[128:143], v[164:167], v[28:31], v[128:143]
    s_add_u32 s60, s60, 4096
    v_exp_f32 v116, v116
    v_exp_f32 v117, v117
    v_exp_f32 v118, v118
    v_exp_f32 v119, v119
    v_cvt_pk_bf16_f32 v146, v116, v117
    v_cvt_pk_bf16_f32 v147, v118, v119
    v_mfma_f32_32x32x16_bf16 v[96:111], v[216:219], v[152:155], v[96:111]
    ds_add_u32 v8, v9
    v_exp_f32 v120, v120
    v_exp_f32 v121, v121
    v_exp_f32 v122, v122
    v_exp_f32 v123, v123
    v_cvt_pk_bf16_f32 v148, v120, v121
    v_cvt_pk_bf16_f32 v149, v122, v123
    v_mfma_f32_32x32x16_bf16 v[96:111], v[220:223], v[156:159], v[96:111]
    v_exp_f32 v124, v124
    v_exp_f32 v125, v125
    v_exp_f32 v126, v126
    v_exp_f32 v127, v127
    v_cvt_pk_bf16_f32 v150, v124, v125
    v_cvt_pk_bf16_f32 v151, v126, v127
    s_sub_u32 s61, s61, 1
    s_cmp_lg_u32 s61, 0
    s_cbranch_scc1 L_attn_18
    v_mfma_f32_32x32x16_bf16 v[112:127], v[160:163], v[32:35], 0
    buffer_load_dwordx4 v[208:211], v2, s[24:27], s60 offen offset:0 sc1
    v_exp_f32 v128, v128
    v_exp_f32 v129, v129
    v_exp_f32 v130, v130
    v_exp_f32 v131, v131
    v_cvt_pk_bf16_f32 v152, v128, v129
    v_cvt_pk_bf16_f32 v153, v130, v131
    v_mfma_f32_32x32x16_bf16 v[112:127], v[164:167], v[36:39], v[112:127]
    v_exp_f32 v132, v132
    v_exp_f32 v133, v133
    v_exp_f32 v134, v134
    v_exp_f32 v135, v135
    v_cvt_pk_bf16_f32 v154, v132, v133
    v_cvt_pk_bf16_f32 v155, v134, v135
    v_mfma_f32_32x32x16_bf16 v[48:63], v[168:171], v[144:147], v[48:63]
    v_exp_f32 v136, v136
    v_exp_f32 v137, v137
    v_exp_f32 v138, v138
    v_exp_f32 v139, v139
    v_cvt_pk_bf16_f32 v156, v136, v137
    v_cvt_pk_bf16_f32 v157, v138, v139
    v_mfma_f32_32x32x16_bf16 v[48:63], v[172:175], v[148:151], v[48:63]
    v_exp_f32 v140, v140
    v_exp_f32 v141, v141
    v_exp_f32 v142, v142
    v_exp_f32 v143, v143
    v_cvt_pk_bf16_f32 v158, v140, v141
    v_cvt_pk_bf16_f32 v159, v142, v143
    v_mfma_f32_32x32x16_bf16 v[128:143], v[160:163], v[40:43], 0
    buffer_load_dwordx4 v[212:215], v2, s[24:27], s60 offen offset:1024 sc1
    v_exp_f32 v112, v112
    v_exp_f32 v113, v113
    v_exp_f32 v114, v114
    v_exp_f32 v115, v115
    v_cvt_pk_bf16_f32 v144, v112, v113
    v_cvt_pk_bf16_f32 v145, v114, v115
    v_mfma_f32_32x32x16_bf16 v[128:143], v[164:167], v[44:47], v[128:143]
    v_exp_f32 v116, v116
    v_exp_f32 v117, v117
    v_exp_f32 v118, v118
    v_exp_f32 v119, v119
    v_cvt_pk_bf16_f32 v146, v116, v117
    v_cvt_pk_bf16_f32 v147, v118, v119
    v_mfma_f32_32x32x16_bf16 v[64:79], v[168:171], v[152:155], v[64:79]
    v_exp_f32 v120, v120
    v_exp_f32 v121, v121
    v_exp_f32 v122, v122
    v_exp_f32 v123, v123
    v_cvt_pk_bf16_f32 v148, v120, v121
    v_cvt_pk_bf16_f32 v149, v122, v123
    v_mfma_f32_32x32x16_bf16 v[64:79], v[172:175], v[156:159], v[64:79]
    s_waitcnt vmcnt(6)
    v_exp_f32 v124, v124
    v_exp_f32 v125, v125
    v_exp_f32 v126, v126
    v_exp_f32 v127, v127
    v_cvt_pk_bf16_f32 v150, v124, v125
    v_cvt_pk_bf16_f32 v151, v126, v127
    v_mfma_f32_32x32x16_bf16 v[112:127], v[176:179], v[16:19], 0
    buffer_load_dwordx4 v[216:219], v2, s[24:27], s60 offen offset:2048 sc1
    v_exp_f32 v128, v128
    v_exp_f32 v129, v129
    v_exp_f32 v130, v130
    v_exp_f32 v131, v131
    v_cvt_pk_bf16_f32 v152, v128, v129
    v_cvt_pk_bf16_f32 v153, v130, v131
    v_mfma_f32_32x32x16_bf16 v[112:127], v[180:183], v[20:23], v[112:127]
    v_exp_f32 v132, v132
    v_exp_f32 v133, v133
    v_exp_f32 v134, v134
    v_exp_f32 v135, v135
    v_cvt_pk_bf16_f32 v154, v132, v133
    v_cvt_pk_bf16_f32 v155, v134, v135
    v_mfma_f32_32x32x16_bf16 v[80:95], v[168:171], v[144:147], v[80:95]
    v_exp_f32 v136, v136
    v_exp_f32 v137, v137
    v_exp_f32 v138, v138
    v_exp_f32 v139, v139
    v_cvt_pk_bf16_f32 v156, v136, v137
    v_cvt_pk_bf16_f32 v157, v138, v139
    v_mfma_f32_32x32x16_bf16 v[80:95], v[172:175], v[148:151], v[80:95]
    v_exp_f32 v140, v140
    v_exp_f32 v141, v141
    v_exp_f32 v142, v142
    v_exp_f32 v143, v143
    v_cvt_pk_bf16_f32 v158, v140, v141
    v_cvt_pk_bf16_f32 v159, v142, v143
    v_mfma_f32_32x32x16_bf16 v[128:143], v[176:179], v[24:27], 0
    buffer_load_dwordx4 v[220:223], v2, s[24:27], s60 offen offset:3072 sc1
    v_exp_f32 v112, v112
    v_exp_f32 v113, v113
    v_exp_f32 v114, v114
    v_exp_f32 v115, v115
    v_cvt_pk_bf16_f32 v144, v112, v113
    v_cvt_pk_bf16_f32 v145, v114, v115
    v_mfma_f32_32x32x16_bf16 v[128:143], v[180:183], v[28:31], v[128:143]
    s_add_u32 s60, s60, 4096
    v_exp_f32 v116, v116
    v_exp_f32 v117, v117
    v_exp_f32 v118, v118
    v_exp_f32 v119, v119
    v_cvt_pk_bf16_f32 v146, v116, v117
    v_cvt_pk_bf16_f32 v147, v118, v119
    v_mfma_f32_32x32x16_bf16 v[96:111], v[168:171], v[152:155], v[96:111]
    ds_add_u32 v8, v9
    v_exp_f32 v120, v120
    v_exp_f32 v121, v121
    v_exp_f32 v122, v122
    v_exp_f32 v123, v123
    v_cvt_pk_bf16_f32 v148, v120, v121
    v_cvt_pk_bf16_f32 v149, v122, v123
    v_mfma_f32_32x32x16_bf16 v[96:111], v[172:175], v[156:159], v[96:111]
    v_exp_f32 v124, v124
    v_exp_f32 v125, v125
    v_exp_f32 v126, v126
    v_exp_f32 v127, v127
    v_cvt_pk_bf16_f32 v150, v124, v125
    v_cvt_pk_bf16_f32 v151, v126, v127
    v_mfma_f32_32x32x16_bf16 v[112:127], v[176:179], v[32:35], 0
    v_exp_f32 v128, v128
    v_exp_f32 v129, v129
    v_exp_f32 v130, v130
    v_exp_f32 v131, v131
    v_cvt_pk_bf16_f32 v152, v128, v129
    v_cvt_pk_bf16_f32 v153, v130, v131
    v_mfma_f32_32x32x16_bf16 v[112:127], v[180:183], v[36:39], v[112:127]
    v_exp_f32 v132, v132
    v_exp_f32 v133, v133
    v_exp_f32 v134, v134
    v_exp_f32 v135, v135
    v_cvt_pk_bf16_f32 v154, v132, v133
    v_cvt_pk_bf16_f32 v155, v134, v135
    v_mfma_f32_32x32x16_bf16 v[48:63], v[184:187], v[144:147], v[48:63]
    v_exp_f32 v136, v136
    v_exp_f32 v137, v137
    v_exp_f32 v138, v138
    v_exp_f32 v139, v139
    v_cvt_pk_bf16_f32 v156, v136, v137
    v_cvt_pk_bf16_f32 v157, v138, v139
    v_mfma_f32_32x32x16_bf16 v[48:63], v[188:191], v[148:151], v[48:63]
    v_exp_f32 v140, v140
    v_exp_f32 v141, v141
    v_exp_f32 v142, v142
    v_exp_f32 v143, v143
    v_cvt_pk_bf16_f32 v158, v140, v141
    v_cvt_pk_bf16_f32 v159, v142, v143
    v_mfma_f32_32x32x16_bf16 v[128:143], v[176:179], v[40:43], 0
    v_exp_f32 v112, v112
    v_exp_f32 v113, v113
    v_exp_f32 v114, v114
    v_exp_f32 v115, v115
    v_cvt_pk_bf16_f32 v144, v112, v113
    v_cvt_pk_bf16_f32 v145, v114, v115
    v_mfma_f32_32x32x16_bf16 v[128:143], v[180:183], v[44:47], v[128:143]
    v_exp_f32 v116, v116
    v_exp_f32 v117, v117
    v_exp_f32 v118, v118
    v_exp_f32 v119, v119
    v_cvt_pk_bf16_f32 v146, v116, v117
    v_cvt_pk_bf16_f32 v147, v118, v119
    v_mfma_f32_32x32x16_bf16 v[64:79], v[184:187], v[152:155], v[64:79]
    v_exp_f32 v120, v120
    v_exp_f32 v121, v121
    v_exp_f32 v122, v122
    v_exp_f32 v123, v123
    v_cvt_pk_bf16_f32 v148, v120, v121
    v_cvt_pk_bf16_f32 v149, v122, v123
    v_mfma_f32_32x32x16_bf16 v[64:79], v[188:191], v[156:159], v[64:79]
    s_waitcnt vmcnt(4)
    v_exp_f32 v124, v124
    v_exp_f32 v125, v125
    v_exp_f32 v126, v126
    v_exp_f32 v127, v127
    v_cvt_pk_bf16_f32 v150, v124, v125
    v_cvt_pk_bf16_f32 v151, v126, v127
    v_mfma_f32_32x32x16_bf16 v[112:127], v[192:195], v[16:19], 0
    v_exp_f32 v128, v128
    v_exp_f32 v129, v129
    v_exp_f32 v130, v130
    v_exp_f32 v131, v131
    v_cvt_pk_bf16_f32 v152, v128, v129
    v_cvt_pk_bf16_f32 v153, v130, v131
    v_mfma_f32_32x32x16_bf16 v[112:127], v[196:199], v[20:23], v[112:127]
    v_exp_f32 v132, v132
    v_exp_f32 v133, v133
    v_exp_f32 v134, v134
    v_exp_f32 v135, v135
    v_cvt_pk_bf16_f32 v154, v132, v133
    v_cvt_pk_bf16_f32 v155, v134, v135
    v_mfma_f32_32x32x16_bf16 v[80:95], v[184:187], v[144:147], v[80:95]
    v_exp_f32 v136, v136
    v_exp_f32 v137, v137
    v_exp_f32 v138, v138
    v_exp_f32 v139, v139
    v_cvt_pk_bf16_f32 v156, v136, v137
    v_cvt_pk_bf16_f32 v157, v138, v139
    v_mfma_f32_32x32x16_bf16 v[80:95], v[188:191], v[148:151], v[80:95]
    v_exp_f32 v140, v140
    v_exp_f32 v141, v141
    v_exp_f32 v142, v142
    v_exp_f32 v143, v143
    v_cvt_pk_bf16_f32 v158, v140, v141
    v_cvt_pk_bf16_f32 v159, v142, v143
    v_mfma_f32_32x32x16_bf16 v[128:143], v[192:195], v[24:27], 0
    v_exp_f32 v112, v112
    v_exp_f32 v113, v113
    v_exp_f32 v114, v114
    v_exp_f32 v115, v115
    v_cvt_pk_bf16_f32 v144, v112, v113
    v_cvt_pk_bf16_f32 v145, v114, v115
    v_mfma_f32_32x32x16_bf16 v[128:143], v[196:199], v[28:31], v[128:143]
    v_exp_f32 v116, v116
    v_exp_f32 v117, v117
    v_exp_f32 v118, v118
    v_exp_f32 v119, v119
    v_cvt_pk_bf16_f32 v146, v116, v117
    v_cvt_pk_bf16_f32 v147, v118, v119
    v_mfma_f32_32x32x16_bf16 v[96:111], v[184:187], v[152:155], v[96:111]
    v_exp_f32 v120, v120
    v_exp_f32 v121, v121
    v_exp_f32 v122, v122
    v_exp_f32 v123, v123
    v_cvt_pk_bf16_f32 v148, v120, v121
    v_cvt_pk_bf16_f32 v149, v122, v123
    v_mfma_f32_32x32x16_bf16 v[96:111], v[188:191], v[156:159], v[96:111]
    v_exp_f32 v124, v124
    v_exp_f32 v125, v125
    v_exp_f32 v126, v126
    v_exp_f32 v127, v127
    v_cvt_pk_bf16_f32 v150, v124, v125
    v_cvt_pk_bf16_f32 v151, v126, v127
    v_mfma_f32_32x32x16_bf16 v[112:127], v[192:195], v[32:35], 0
    v_exp_f32 v128, v128
    v_exp_f32 v129, v129
    v_exp_f32 v130, v130
    v_exp_f32 v131, v131
    v_cvt_pk_bf16_f32 v152, v128, v129
    v_cvt_pk_bf16_f32 v153, v130, v131
    v_mfma_f32_32x32x16_bf16 v[112:127], v[196:199], v[36:39], v[112:127]
    v_exp_f32 v132, v132
    v_exp_f32 v133, v133
    v_exp_f32 v134, v134
    v_exp_f32 v135, v135
    v_cvt_pk_bf16_f32 v154, v132, v133
    v_cvt_pk_bf16_f32 v155, v134, v135
    v_mfma_f32_32x32x16_bf16 v[48:63], v[200:203], v[144:147], v[48:63]
    v_exp_f32 v136, v136
    v_exp_f32 v137, v137
    v_exp_f32 v138, v138
    v_exp_f32 v139, v139
    v_cvt_pk_bf16_f32 v156, v136, v137
    v_cvt_pk_bf16_f32 v157, v138, v139
    v_mfma_f32_32x32x16_bf16 v[48:63], v[204:207], v[148:151], v[48:63]
    v_exp_f32 v140, v140
    v_exp_f32 v141, v141
    v_exp_f32 v142, v142
    v_exp_f32 v143, v143
    v_cvt_pk_bf16_f32 v158, v140, v141
    v_cvt_pk_bf16_f32 v159, v142, v143
    v_mfma_f32_32x32x16_bf16 v[128:143], v[192:195], v[40:43], 0
    v_exp_f32 v112, v112
    v_exp_f32 v113, v113
    v_exp_f32 v114, v114
    v_exp_f32 v115, v115
    v_cvt_pk_bf16_f32 v144, v112, v113
    v_cvt_pk_bf16_f32 v145, v114, v115
    v_mfma_f32_32x32x16_bf16 v[128:143], v[196:199], v[44:47], v[128:143]
    v_exp_f32 v116, v116
    v_exp_f32 v117, v117
    v_exp_f32 v118, v118
    v_exp_f32 v119, v119
    v_cvt_pk_bf16_f32 v146, v116, v117
    v_cvt_pk_bf16_f32 v147, v118, v119
    v_mfma_f32_32x32x16_bf16 v[64:79], v[200:203], v[152:155], v[64:79]
    v_exp_f32 v120, v120
    v_exp_f32 v121, v121
    v_exp_f32 v122, v122
    v_exp_f32 v123, v123
    v_cvt_pk_bf16_f32 v148, v120, v121
    v_cvt_pk_bf16_f32 v149, v122, v123
    v_mfma_f32_32x32x16_bf16 v[64:79], v[204:207], v[156:159], v[64:79]
    s_waitcnt vmcnt(0)
    v_exp_f32 v124, v124
    v_exp_f32 v125, v125
    v_exp_f32 v126, v126
    v_exp_f32 v127, v127
    v_cvt_pk_bf16_f32 v150, v124, v125
    v_cvt_pk_bf16_f32 v151, v126, v127
    v_mfma_f32_32x32x16_bf16 v[112:127], v[208:211], v[16:19], 0
    v_exp_f32 v128, v128
    v_exp_f32 v129, v129
    v_exp_f32 v130, v130
    v_exp_f32 v131, v131
    v_cvt_pk_bf16_f32 v152, v128, v129
    v_cvt_pk_bf16_f32 v153, v130, v131
    v_mfma_f32_32x32x16_bf16 v[112:127], v[212:215], v[20:23], v[112:127]
    v_exp_f32 v132, v132
    v_exp_f32 v133, v133
    v_exp_f32 v134, v134
    v_exp_f32 v135, v135
    v_cvt_pk_bf16_f32 v154, v132, v133
    v_cvt_pk_bf16_f32 v155, v134, v135
    v_mfma_f32_32x32x16_bf16 v[80:95], v[200:203], v[144:147], v[80:95]
    v_exp_f32 v136, v136
    v_exp_f32 v137, v137
    v_exp_f32 v138, v138
    v_exp_f32 v139, v139
    v_cvt_pk_bf16_f32 v156, v136, v137
    v_cvt_pk_bf16_f32 v157, v138, v139
    v_mfma_f32_32x32x16_bf16 v[80:95], v[204:207], v[148:151], v[80:95]
    v_exp_f32 v140, v140
    v_exp_f32 v141, v141
    v_exp_f32 v142, v142
    v_exp_f32 v143, v143
    v_cvt_pk_bf16_f32 v158, v140, v141
    v_cvt_pk_bf16_f32 v159, v142, v143
    v_mfma_f32_32x32x16_bf16 v[128:143], v[208:211], v[24:27], 0
    v_exp_f32 v112, v112
    v_exp_f32 v113, v113
    v_exp_f32 v114, v114
    v_exp_f32 v115, v115
    v_cvt_pk_bf16_f32 v144, v112, v113
    v_cvt_pk_bf16_f32 v145, v114, v115
    v_mfma_f32_32x32x16_bf16 v[128:143], v[212:215], v[28:31], v[128:143]
    v_exp_f32 v116, v116
    v_exp_f32 v117, v117
    v_exp_f32 v118, v118
    v_exp_f32 v119, v119
    v_cvt_pk_bf16_f32 v146, v116, v117
    v_cvt_pk_bf16_f32 v147, v118, v119
    v_mfma_f32_32x32x16_bf16 v[96:111], v[200:203], v[152:155], v[96:111]
    v_exp_f32 v120, v120
    v_exp_f32 v121, v121
    v_exp_f32 v122, v122
    v_exp_f32 v123, v123
    v_cvt_pk_bf16_f32 v148, v120, v121
    v_cvt_pk_bf16_f32 v149, v122, v123
    v_mfma_f32_32x32x16_bf16 v[96:111], v[204:207], v[156:159], v[96:111]
    v_exp_f32 v124, v124
    v_exp_f32 v125, v125
    v_exp_f32 v126, v126
    v_exp_f32 v127, v127
    v_cvt_pk_bf16_f32 v150, v124, v125
    v_cvt_pk_bf16_f32 v151, v126, v127
    v_mfma_f32_32x32x16_bf16 v[112:127], v[208:211], v[32:35], 0
    v_exp_f32 v128, v128
    v_exp_f32 v129, v129
    v_exp_f32 v130, v130
    v_exp_f32 v131, v131
    v_cvt_pk_bf16_f32 v152, v128, v129
    v_cvt_pk_bf16_f32 v153, v130, v131
    v_mfma_f32_32x32x16_bf16 v[112:127], v[212:215], v[36:39], v[112:127]
    v_exp_f32 v132, v132
    v_exp_f32 v133, v133
    v_exp_f32 v134, v134
    v_exp_f32 v135, v135
    v_cvt_pk_bf16_f32 v154, v132, v133
    v_cvt_pk_bf16_f32 v155, v134, v135
    v_mfma_f32_32x32x16_bf16 v[48:63], v[216:219], v[144:147], v[48:63]
    v_exp_f32 v136, v136
    v_exp_f32 v137, v137
    v_exp_f32 v138, v138
    v_exp_f32 v139, v139
    v_cvt_pk_bf16_f32 v156, v136, v137
    v_cvt_pk_bf16_f32 v157, v138, v139
    v_mfma_f32_32x32x16_bf16 v[48:63], v[220:223], v[148:151], v[48:63]
    v_exp_f32 v140, v140
    v_exp_f32 v141, v141
    v_exp_f32 v142, v142
    v_exp_f32 v143, v143
    v_cvt_pk_bf16_f32 v158, v140, v141
    v_cvt_pk_bf16_f32 v159, v142, v143
    v_mfma_f32_32x32x16_bf16 v[128:143], v[208:211], v[40:43], 0
    v_exp_f32 v112, v112
    v_exp_f32 v113, v113
    v_exp_f32 v114, v114
    v_exp_f32 v115, v115
    v_cvt_pk_bf16_f32 v144, v112, v113
    v_cvt_pk_bf16_f32 v145, v114, v115
    v_mfma_f32_32x32x16_bf16 v[128:143], v[212:215], v[44:47], v[128:143]
    v_exp_f32 v116, v116
    v_exp_f32 v117, v117
    v_exp_f32 v118, v118
    v_exp_f32 v119, v119
    v_cvt_pk_bf16_f32 v146, v116, v117
    v_cvt_pk_bf16_f32 v147, v118, v119
    v_mfma_f32_32x32x16_bf16 v[64:79], v[216:219], v[152:155], v[64:79]
    v_exp_f32 v120, v120
    v_exp_f32 v121, v121
    v_exp_f32 v122, v122
    v_exp_f32 v123, v123
    v_cvt_pk_bf16_f32 v148, v120, v121
    v_cvt_pk_bf16_f32 v149, v122, v123
    v_mfma_f32_32x32x16_bf16 v[64:79], v[220:223], v[156:159], v[64:79]
    v_exp_f32 v124, v124
    v_exp_f32 v125, v125
    v_exp_f32 v126, v126
    v_exp_f32 v127, v127
    v_cvt_pk_bf16_f32 v150, v124, v125
    v_cvt_pk_bf16_f32 v151, v126, v127
    v_exp_f32 v128, v128
    v_exp_f32 v129, v129
    v_exp_f32 v130, v130
    v_exp_f32 v131, v131
    v_cvt_pk_bf16_f32 v152, v128, v129
    v_cvt_pk_bf16_f32 v153, v130, v131
    v_exp_f32 v132, v132
    v_exp_f32 v133, v133
    v_exp_f32 v134, v134
    v_exp_f32 v135, v135
    v_cvt_pk_bf16_f32 v154, v132, v133
    v_cvt_pk_bf16_f32 v155, v134, v135
    v_mfma_f32_32x32x16_bf16 v[80:95], v[216:219], v[144:147], v[80:95]
    v_exp_f32 v136, v136
    v_exp_f32 v137, v137
    v_exp_f32 v138, v138
    v_exp_f32 v139, v139
    v_cvt_pk_bf16_f32 v156, v136, v137
    v_cvt_pk_bf16_f32 v157, v138, v139
    v_mfma_f32_32x32x16_bf16 v[80:95], v[220:223], v[148:151], v[80:95]
    v_exp_f32 v140, v140
    v_exp_f32 v141, v141
    v_exp_f32 v142, v142
    v_exp_f32 v143, v143
    v_cvt_pk_bf16_f32 v158, v140, v141
    v_cvt_pk_bf16_f32 v159, v142, v143
    s_nop 1
    v_mfma_f32_32x32x16_bf16 v[96:111], v[216:219], v[152:155], v[96:111]
    v_mfma_f32_32x32x16_bf16 v[96:111], v[220:223], v[156:159], v[96:111]
    s_setprio 3
    s_nop 7
    s_nop 5
    v_mov_b32 v12, 159768
    v_mov_b32 v13, 1
    s_mov_b64 exec, 1
    ds_add_u32 v12, v13
    s_mov_b64 exec, -1
    v_mov_b32 v12, 159764
    s_mov_b32 s48, 0x400000
L_lw_19:
    ds_read_b32 v13, v12
    s_waitcnt lgkmcnt(0)
    v_readfirstlane_b32 s49, v13
    s_sub_u32 s48, s48, 1
    s_cbranch_scc1 L_lwd_20
    s_cmp_ge_u32 s49, 4
    s_cbranch_scc1 L_lwd_20
    s_branch L_lw_19
L_lwd_20:
    v_lshlrev_b32 v14, 2, v1
    s_xor_b32 s48, s3, 1
    s_mul_i32 s48, s48, 11136
    s_add_u32 s48, s48, 114688
    v_add_u32 v12, s48, v2
    v_add_u32 v13, s48, v14
    ds_write_b128 v12, v[48:51] offset:0
    ds_write_b128 v12, v[52:55] offset:1024
    ds_write_b128 v12, v[56:59] offset:2048
    s_mov_b32 exec_hi, 0
    ds_write_b128 v12, v[60:63] offset:3072
    s_mov_b64 exec, s[46:47]
    ds_write_b32 v13, v60 offset:3456
    s_mov_b64 exec, -1
    s_xor_b32 s48, s3, 2
    s_mul_i32 s48, s48, 11136
    s_add_u32 s48, s48, 118400
    v_add_u32 v12, s48, v2
    v_add_u32 v13, s48, v14
    ds_write_b128 v12, v[64:67] offset:0
    ds_write_b128 v12, v[68:71] offset:1024
    ds_write_b128 v12, v[72:75] offset:2048
    s_mov_b32 exec_hi, 0
    ds_write_b128 v12, v[76:79] offset:3072
    s_mov_b64 exec, s[46:47]
    ds_write_b32 v13, v76 offset:3456
    s_mov_b64 exec, -1
    s_xor_b32 s48, s3, 3
    s_mul_i32 s48, s48, 11136
    s_add_u32 s48, s48, 122112
    v_add_u32 v12, s48, v2
    v_add_u32 v13, s48, v14
    ds_write_b128 v12, v[80:83] offset:0
    ds_write_b128 v12, v[84:87] offset:1024
    ds_write_b128 v12, v[88:91] offset:2048
    s_mov_b32 exec_hi, 0
    ds_write_b128 v12, v[92:95] offset:3072
    s_mov_b64 exec, s[46:47]
    ds_write_b32 v13, v92 offset:3456
    s_mov_b64 exec, -1
    v_cmp_eq_u32 vcc, -1, v15
    s_waitcnt lgkmcnt(0)
    s_cmp_lg_u64 vcc, 0
    s_cselect_b32 s48, 0x10001, 1
    s_mov_b32 s48, 1
    v_mov_b32 v12, 159744
    v_mov_b32 v13, s48
    s_mov_b64 exec, 1
    ds_add_u32 v12, v13
    s_mov_b64 exec, -1
    s_add_u32 s55, s55, 1
    s_lshl_b32 s51, s55, 2
    s_mov_b32 s49, 0x400000
L_w0_21:
    ds_read_b32 v13, v12
    s_waitcnt lgkmcnt(0)
    v_readfirstlane_b32 s48, v13
    s_sub_u32 s49, s49, 1
    s_cbranch_scc1 L_w0d_22
    s_and_b32 s50, s48, 0xffff
    s_cmp_lt_u32 s50, s51
    s_cbranch_scc1 L_w0_21
L_w0d_22:
    s_lshr_b32 s48, s48, 16
    s_cmp_lg_u32 s48, s54
    s_mov_b32 s54, s48
    s_cbranch_scc0 L_nosent_23
    s_cmp_ge_u32 s55, 32
    s_cbranch_scc1 L_nosent_23
    v_mov_b32 v48, 0
    v_mov_b32 v49, 0
    v_mov_b32 v50, 0
    v_mov_b32 v51, 0
    v_mov_b32 v52, 0
    v_mov_b32 v53, 0
    v_mov_b32 v54, 0
    v_mov_b32 v55, 0
    v_mov_b32 v56, 0
    v_mov_b32 v57, 0
    v_mov_b32 v58, 0
    v_mov_b32 v59, 0
    v_mov_b32 v60, 0
    v_mov_b32 v61, 0
    v_mov_b32 v62, 0
    v_mov_b32 v63, 0
    v_mov_b32 v64, 0
    v_mov_b32 v65, 0
    v_mov_b32 v66, 0
    v_mov_b32 v67, 0
    v_mov_b32 v68, 0
    v_mov_b32 v69, 0
    v_mov_b32 v70, 0
    v_mov_b32 v71, 0
    v_mov_b32 v72, 0
    v_mov_b32 v73, 0
    v_mov_b32 v74, 0
    v_mov_b32 v75, 0
    v_mov_b32 v76, 0
    v_mov_b32 v77, 0
    v_mov_b32 v78, 0
    v_mov_b32 v79, 0
    v_mov_b32 v80, 0
    v_mov_b32 v81, 0
    v_mov_b32 v82, 0
    v_mov_b32 v83, 0
    v_mov_b32 v84, 0
    v_mov_b32 v85, 0
    v_mov_b32 v86, 0
    v_mov_b32 v87, 0
    v_mov_b32 v88, 0
    v_mov_b32 v89, 0
    v_mov_b32 v90, 0
    v_mov_b32 v91, 0
    v_mov_b32 v92, 0
    v_mov_b32 v93, 0
    v_mov_b32 v94, 0
    v_mov_b32 v95, 0
    v_mov_b32 v96, 0
    v_mov_b32 v97, 0
    v_mov_b32 v98, 0
    v_mov_b32 v99, 0
    v_mov_b32 v100, 0
    v_mov_b32 v101, 0
    v_mov_b32 v102, 0
    v_mov_b32 v103, 0
    v_mov_b32 v104, 0
    v_mov_b32 v105, 0
    v_mov_b32 v106, 0
    v_mov_b32 v107, 0
    v_mov_b32 v108, 0
    v_mov_b32 v109, 0
    v_mov_b32 v110, 0
    v_mov_b32 v111, 0
    s_mov_b32 s53, 1
    s_setprio 1
    s_branch L_attn_entry
L_nosent_23:
    s_lshl_b32 s57, s59, 2
    s_add_u32 s57, s57, 4
    s_mul_i32 s48, s3, 11136
    s_add_u32 s48, s48, 114688
    v_add_u32 v12, s48, v2
    v_add_u32 v13, s48, v14
    ds_read_b128 v[160:163], v12 offset:0
    ds_read_b128 v[164:167], v12 offset:1024
    ds_read_b128 v[168:171], v12 offset:2048
    s_mov_b32 exec_hi, 0
    ds_read_b128 v[172:175], v12 offset:3072
    s_mov_b64 exec, s[46:47]
    ds_read_b32 v172, v13 offset:3456
    s_mov_b64 exec, -1
    ds_read_b128 v[176:179], v12 offset:3712
    ds_read_b128 v[180:183], v12 offset:4736
    ds_read_b128 v[184:187], v12 offset:5760
    s_mov_b32 exec_hi, 0
    ds_read_b128 v[188:191], v12 offset:6784
    s_mov_b64 exec, s[46:47]
    ds_read_b32 v188, v13 offset:7168
    s_mov_b64 exec, -1
    ds_read_b128 v[192:195], v12 offset:7424
    ds_read_b128 v[196:199], v12 offset:8448
    ds_read_b128 v[200:203], v12 offset:9472
    s_mov_b32 exec_hi, 0
    ds_read_b128 v[204:207], v12 offset:10496
    s_mov_b64 exec, s[46:47]
    ds_read_b32 v204, v13 offset:10880
    s_mov_b64 exec, -1
    s_waitcnt lgkmcnt(10)
    v_add_f32 v96, v96, v160
    v_add_f32 v97, v97, v161
    v_add_f32 v98, v98, v162
    v_add_f32 v99, v99, v163
    v_add_f32 v100, v100, v164
    v_add_f32 v101, v101, v165
    v_add_f32 v102, v102, v166
    v_add_f32 v103, v103, v167
    v_add_f32 v104, v104, v168
    v_add_f32 v105, v105, v169
    v_add_f32 v106, v106, v170
    v_add_f32 v107, v107, v171
    v_add_f32 v108, v108, v172
    v_add_f32 v109, v109, v173
    v_add_f32 v110, v110, v174
    v_add_f32 v111, v111, v175
    s_waitcnt lgkmcnt(5)
    v_add_f32 v96, v96, v176
    v_add_f32 v97, v97, v177
    v_add_f32 v98, v98, v178
    v_add_f32 v99, v99, v179
    v_add_f32 v100, v100, v180
    v_add_f32 v101, v101, v181
    v_add_f32 v102, v102, v182
    v_add_f32 v103, v103, v183
    v_add_f32 v104, v104, v184
    v_add_f32 v105, v105, v185
    v_add_f32 v106, v106, v186
    v_add_f32 v107, v107, v187
    v_add_f32 v108, v108, v188
    v_add_f32 v109, v109, v189
    v_add_f32 v110, v110, v190
    v_add_f32 v111, v111, v191
    s_waitcnt lgkmcnt(0)
    v_add_f32 v96, v96, v192
    v_add_f32 v97, v97, v193
    v_add_f32 v98, v98, v194
    v_add_f32 v99, v99, v195
    v_add_f32 v100, v100, v196
    v_add_f32 v101, v101, v197
    v_add_f32 v102, v102, v198
    v_add_f32 v103, v103, v199
    v_add_f32 v104, v104, v200
    v_add_f32 v105, v105, v201
    v_add_f32 v106, v106, v202
    v_add_f32 v107, v107, v203
    v_add_f32 v108, v108, v204
    v_add_f32 v109, v109, v205
    v_add_f32 v110, v110, v206
    v_add_f32 v111, v111, v207
    v_mov_b32 v12, v108
    v_mov_b32 v13, v108
    s_nop 1
    v_permlane32_swap_b32 v12, v13
    s_nop 1
    s_mov_b32 s48, 0x2b800000
    s_mov_b32 s49, 0x7f800000
    v_cmp_le_f32 s[50:51], s48, v13
    v_cmp_gt_f32 vcc, s49, v13
    v_rcp_f32 v13, v13
    s_nop 1
    s_and_b64 vcc, vcc, s[50:51]
    s_cmp_eq_u64 vcc, -1
    s_cselect_b32 s56, 0, 1
    s_cmp_eq_u32 s59, 0
    s_cselect_b32 s56, s56, 0
    s_lshl_b32 s48, s56, 8
    s_add_u32 s48, s48, 1
    v_mov_b32 v14, s48
    v_mov_b32 v15, 159780
    s_mov_b64 exec, 1
    ds_add_u32 v15, v14
    s_mov_b64 exec, -1
    s_or_b32 s48, s56, s58
    s_cmp_lg_u32 s48, 0
    s_cbranch_scc1 L_nopub_24
    v_mul_f32 v12, v13, v10
    v_mul_f32 v13, v13, v10
    v_mul_f32 v96, v12, v96
    v_mul_f32 v97, v12, v97
    v_mul_f32 v98, v12, v98
    v_mul_f32 v99, v12, v99
    v_mul_f32 v100, v12, v100
    v_mul_f32 v101, v12, v101
    v_mul_f32 v102, v12, v102
    v_mul_f32 v103, v12, v103
    v_mul_f32 v104, v12, v104
    v_mul_f32 v105, v12, v105
    v_mul_f32 v106, v12, v106
    v_mul_f32 v107, v12, v107
    v_mul_f32 v108, v12, v108
    v_mul_f32 v109, v12, v109
    v_mul_f32 v110, v12, v110
    v_mul_f32 v111, v12, v111
    v_cvt_pk_bf16_f32 v144, v96, v97
    v_cvt_pk_bf16_f32 v145, v98, v99
    v_cvt_pk_bf16_f32 v146, v100, v101
    v_cvt_pk_bf16_f32 v147, v102, v103
    v_cvt_pk_bf16_f32 v148, v104, v105
    v_cvt_pk_bf16_f32 v149, v106, v107
    v_cvt_pk_bf16_f32 v150, v108, v109
    v_cvt_pk_bf16_f32 v151, v110, v111
    v_cndmask_b32 v150, v150, v247, s[46:47]
    v_cndmask_b32 v151, v151, v247, s[46:47]
    s_lshl_b32 s48, s4, 1
    s_lshr_b32 s49, s3, 1
    s_add_u32 s48, s48, s49
    s_lshl_b32 s48, s48, 4
    s_lshl_b32 s49, s5, 1
    s_add_u32 s48, s48, s49
    s_and_b32 s49, s3, 1
    s_add_u32 s48, s48, s49
    s_lshl_b32 s48, s48, 11
    s_add_u32 s52, s48, 4718592
    buffer_store_dwordx4 v[144:147], v2, s[24:27], s52 offen sc1
    buffer_store_dwordx4 v[148:151], v2, s[24:27], s52 offen offset:1024 sc1
    s_mov_b32 s58, 1
L_nopub_24:
    v_mov_b32 v12, 159780
    s_mov_b32 s49, 0x400000
L_vd_25:
    ds_read_b32 v13, v12
    s_waitcnt lgkmcnt(0)
    v_readfirstlane_b32 s48, v13
    s_sub_u32 s49, s49, 1
    s_cbranch_scc1 L_vdd_26
    s_and_b32 s50, s48, 0xff
    s_cmp_lt_u32 s50, s57
    s_cbranch_scc1 L_vd_25
L_vdd_26:
    s_lshr_b32 s48, s48, 8
    s_cmp_eq_u32 s59, 0
    s_cselect_b32 s48, s48, 0
    s_cmp_lg_u32 s48, 0
    s_cbranch_scc1 L_redo
    v_mov_b32 v12, 159760
    v_mov_b32 v13, 1
    s_mov_b64 exec, 1
    ds_add_u32 v12, v13
    s_mov_b64 exec, -1
    s_endpgm
L_redo:
    v_cndmask_b32 v22, v22, v247, s[46:47]
    v_cndmask_b32 v23, v23, v247, s[46:47]
    v_mov_b32 v128, 0xff800000
    v_cndmask_b32 v30, v30, v247, s[46:47]
    v_cndmask_b32 v31, v31, v247, s[46:47]
    v_mov_b32 v129, 0xff800000
    v_cndmask_b32 v38, v38, v247, s[46:47]
    v_cndmask_b32 v39, v39, v247, s[46:47]
    v_mov_b32 v130, 0xff800000
    v_cndmask_b32 v46, v46, v247, s[46:47]
    v_cndmask_b32 v47, v47, v247, s[46:47]
    v_mov_b32 v131, 0xff800000
    s_lshl_b32 s60, s3, 16
    s_add_u32 s60, s60, 0
    s_mov_b32 s61, 16
L_mx:
    buffer_load_dwordx4 v[160:163], v2, s[24:27], s60 offen sc1
    buffer_load_dwordx4 v[164:167], v2, s[24:27], s60 offen offset:1024 sc1
    s_waitcnt vmcnt(0)
    v_mfma_f32_32x32x16_bf16 v[112:127], v[160:163], v[16:19], 0
    v_mfma_f32_32x32x16_bf16 v[112:127], v[164:167], v[20:23], v[112:127]
    s_nop 7
    s_nop 7
    v_max3_f32 v128, v128, v112, v113
    v_max3_f32 v128, v128, v114, v115
    v_max3_f32 v128, v128, v116, v117
    v_max3_f32 v128, v128, v118, v119
    v_max3_f32 v128, v128, v120, v121
    v_max3_f32 v128, v128, v122, v123
    v_max3_f32 v128, v128, v124, v125
    v_max3_f32 v128, v128, v126, v127
    v_mfma_f32_32x32x16_bf16 v[112:127], v[160:163], v[24:27], 0
    v_mfma_f32_32x32x16_bf16 v[112:127], v[164:167], v[28:31], v[112:127]
    s_nop 7
    s_nop 7
    v_max3_f32 v129, v129, v112, v113
    v_max3_f32 v129, v129, v114, v115
    v_max3_f32 v129, v129, v116, v117
    v_max3_f32 v129, v129, v118, v119
    v_max3_f32 v129, v129, v120, v121
    v_max3_f32 v129, v129, v122, v123
    v_max3_f32 v129, v129, v124, v125
    v_max3_f32 v129, v129, v126, v127
    v_mfma_f32_32x32x16_bf16 v[112:127], v[160:163], v[32:35], 0
    v_mfma_f32_32x32x16_bf16 v[112:127], v[164:167], v[36:39], v[112:127]
    s_nop 7
    s_nop 7
    v_max3_f32 v130, v130, v112, v113
    v_max3_f32 v130, v130, v114, v115
    v_max3_f32 v130, v130, v116, v117
    v_max3_f32 v130, v130, v118, v119
    v_max3_f32 v130, v130, v120, v121
    v_max3_f32 v130, v130, v122, v123
    v_max3_f32 v130, v130, v124, v125
    v_max3_f32 v130, v130, v126, v127
    v_mfma_f32_32x32x16_bf16 v[112:127], v[160:163], v[40:43], 0
    v_mfma_f32_32x32x16_bf16 v[112:127], v[164:167], v[44:47], v[112:127]
    s_nop 7
    s_nop 7
    v_max3_f32 v131, v131, v112, v113
    v_max3_f32 v131, v131, v114, v115
    v_max3_f32 v131, v131, v116, v117
    v_max3_f32 v131, v131, v118, v119
    v_max3_f32 v131, v131, v120, v121
    v_max3_f32 v131, v131, v122, v123
    v_max3_f32 v131, v131, v124, v125
    v_max3_f32 v131, v131, v126, v127
    s_add_u32 s60, s60, 4096
    s_sub_u32 s61, s61, 1
    s_cmp_lg_u32 s61, 0
    s_cbranch_scc1 L_mx
    v_and_b32 v14, 31, v1
    v_lshlrev_b32 v14, 2, v14
    v_mov_b32 v12, v128
    s_nop 1
    v_permlane32_swap_b32 v128, v12
    s_nop 1
    v_max_f32 v128, v128, v12
    s_xor_b32 s48, s3, 1
    s_lshl_b32 s48, s48, 2
    s_add_u32 s48, s48, s3
    s_lshl_b32 s48, s48, 7
    s_add_u32 s48, s48, 114688
    v_add_u32 v15, s48, v14
    ds_write_b32 v15, v128
    v_mov_b32 v12, v129
    s_nop 1
    v_permlane32_swap_b32 v129, v12
    s_nop 1
    v_max_f32 v129, v129, v12
    s_xor_b32 s48, s3, 2
    s_lshl_b32 s48, s48, 2
    s_add_u32 s48, s48, s3
    s_lshl_b32 s48, s48, 7
    s_add_u32 s48, s48, 114688
    v_add_u32 v15, s48, v14
    ds_write_b32 v15, v129
    v_mov_b32 v12, v130
    s_nop 1
    v_permlane32_swap_b32 v130, v12
    s_nop 1
    v_max_f32 v130, v130, v12
    s_xor_b32 s48, s3, 3
    s_lshl_b32 s48, s48, 2
    s_add_u32 s48, s48, s3
    s_lshl_b32 s48, s48, 7
    s_add_u32 s48, s48, 114688
    v_add_u32 v15, s48, v14
    ds_write_b32 v15, v130
    v_mov_b32 v12, v131
    s_nop 1
    v_permlane32_swap_b32 v131, v12
    s_nop 1
    v_max_f32 v131, v131, v12
    s_xor_b32 s48, s3, 0
    s_lshl_b32 s48, s48, 2
    s_add_u32 s48, s48, s3
    s_lshl_b32 s48, s48, 7
    s_add_u32 s48, s48, 114688
    v_add_u32 v15, s48, v14
    ds_write_b32 v15, v131
    s_waitcnt lgkmcnt(0)
    v_mov_b32 v12, 159788
    v_mov_b32 v13, 1
    s_mov_b64 exec, 1
    ds_add_u32 v12, v13
    s_mov_b64 exec, -1
    v_mov_b32 v12, 159788
    s_mov_b32 s48, 0x400000
L_lw_27:
    ds_read_b32 v13, v12
    s_waitcnt lgkmcnt(0)
    v_readfirstlane_b32 s49, v13
    s_sub_u32 s48, s48, 1
    s_cbranch_scc1 L_lwd_28
    s_cmp_ge_u32 s49, 4
    s_cbranch_scc1 L_lwd_28
    s_branch L_lw_27
L_lwd_28:
    s_xor_b32 s48, s3, 1
    s_lshl_b32 s48, s48, 9
    s_add_u32 s48, s48, 114688
    v_add_u32 v15, s48, v14
    ds_read_b32 v112, v15 offset:0
    ds_read_b32 v113, v15 offset:128
    ds_read_b32 v114, v15 offset:256
    ds_read_b32 v115, v15 offset:384
    s_waitcnt lgkmcnt(0)
    v_max3_f32 v12, v112, v113, v114
    v_max_f32 v12, v12, v115
    v_sub_f32 v12, 0, v12
    v_and_b32 v13, 0xffff0000, v12
    v_sub_f32 v12, v12, v13
    v_and_b32 v15, 0xffff0000, v12
    v_sub_f32 v12, v12, v15
    v_lshrrev_b32 v13, 16, v13
    v_or_b32 v13, v13, v15
    v_lshrrev_b32 v12, 16, v12
    v_cndmask_b32 v22, v22, v13, s[46:47]
    v_cndmask_b32 v23, v23, v12, s[46:47]
    s_xor_b32 s48, s3, 2
    s_lshl_b32 s48, s48, 9
    s_add_u32 s48, s48, 114688
    v_add_u32 v15, s48, v14
    ds_read_b32 v112, v15 offset:0
    ds_read_b32 v113, v15 offset:128
    ds_read_b32 v114, v15 offset:256
    ds_read_b32 v115, v15 offset:384
    s_waitcnt lgkmcnt(0)
    v_max3_f32 v12, v112, v113, v114
    v_max_f32 v12, v12, v115
    v_sub_f32 v12, 0, v12
    v_and_b32 v13, 0xffff0000, v12
    v_sub_f32 v12, v12, v13
    v_and_b32 v15, 0xffff0000, v12
    v_sub_f32 v12, v12, v15
    v_lshrrev_b32 v13, 16, v13
    v_or_b32 v13, v13, v15
    v_lshrrev_b32 v12, 16, v12
    v_cndmask_b32 v30, v30, v13, s[46:47]
    v_cndmask_b32 v31, v31, v12, s[46:47]
    s_xor_b32 s48, s3, 3
    s_lshl_b32 s48, s48, 9
    s_add_u32 s48, s48, 114688
    v_add_u32 v15, s48, v14
    ds_read_b32 v112, v15 offset:0
    ds_read_b32 v113, v15 offset:128
    ds_read_b32 v114, v15 offset:256
    ds_read_b32 v115, v15 offset:384
    s_waitcnt lgkmcnt(0)
    v_max3_f32 v12, v112, v113, v114
    v_max_f32 v12, v12, v115
    v_sub_f32 v12, 0, v12
    v_and_b32 v13, 0xffff0000, v12
    v_sub_f32 v12, v12, v13
    v_and_b32 v15, 0xffff0000, v12
    v_sub_f32 v12, v12, v15
    v_lshrrev_b32 v13, 16, v13
    v_or_b32 v13, v13, v15
    v_lshrrev_b32 v12, 16, v12
    v_cndmask_b32 v38, v38, v13, s[46:47]
    v_cndmask_b32 v39, v39, v12, s[46:47]
    s_xor_b32 s48, s3, 0
    s_lshl_b32 s48, s48, 9
    s_add_u32 s48, s48, 114688
    v_add_u32 v15, s48, v14
    ds_read_b32 v112, v15 offset:0
    ds_read_b32 v113, v15 offset:128
    ds_read_b32 v114, v15 offset:256
    ds_read_b32 v115, v15 offset:384
    s_waitcnt lgkmcnt(0)
    v_max3_f32 v12, v112, v113, v114
    v_max_f32 v12, v12, v115
    v_sub_f32 v12, 0, v12
    v_and_b32 v13, 0xffff0000, v12
    v_sub_f32 v12, v12, v13
    v_and_b32 v15, 0xffff0000, v12
    v_sub_f32 v12, v12, v15
    v_lshrrev_b32 v13, 16, v13
    v_or_b32 v13, v13, v15
    v_lshrrev_b32 v12, 16, v12
    v_cndmask_b32 v46, v46, v13, s[46:47]
    v_cndmask_b32 v47, v47, v12, s[46:47]
    v_mov_b32 v12, 159792
    v_mov_b32 v13, 1
    s_mov_b64 exec, 1
    ds_add_u32 v12, v13
    s_mov_b64 exec, -1
    v_mov_b32 v12, 159792
    s_mov_b32 s48, 0x400000
L_lw_29:
    ds_read_b32 v13, v12
    s_waitcnt lgkmcnt(0)
    v_readfirstlane_b32 s49, v13
    s_sub_u32 s48, s48, 1
    s_cbranch_scc1 L_lwd_30
    s_cmp_ge_u32 s49, 4
    s_cbranch_scc1 L_lwd_30
    s_branch L_lw_29
L_lwd_30:
    v_mov_b32 v48, 0
    v_mov_b32 v49, 0
    v_mov_b32 v50, 0
    v_mov_b32 v51, 0
    v_mov_b32 v52, 0
    v_mov_b32 v53, 0
    v_mov_b32 v54, 0
    v_mov_b32 v55, 0
    v_mov_b32 v56, 0
    v_mov_b32 v57, 0
    v_mov_b32 v58, 0
    v_mov_b32 v59, 0
    v_mov_b32 v60, 0
    v_mov_b32 v61, 0
    v_mov_b32 v62, 0
    v_mov_b32 v63, 0
    v_mov_b32 v64, 0
    v_mov_b32 v65, 0
    v_mov_b32 v66, 0
    v_mov_b32 v67, 0
    v_mov_b32 v68, 0
    v_mov_b32 v69, 0
    v_mov_b32 v70, 0
    v_mov_b32 v71, 0
    v_mov_b32 v72, 0
    v_mov_b32 v73, 0
    v_mov_b32 v74, 0
    v_mov_b32 v75, 0
    v_mov_b32 v76, 0
    v_mov_b32 v77, 0
    v_mov_b32 v78, 0
    v_mov_b32 v79, 0
    v_mov_b32 v80, 0
    v_mov_b32 v81, 0
    v_mov_b32 v82, 0
    v_mov_b32 v83, 0
    v_mov_b32 v84, 0
    v_mov_b32 v85, 0
    v_mov_b32 v86, 0
    v_mov_b32 v87, 0
    v_mov_b32 v88, 0
    v_mov_b32 v89, 0
    v_mov_b32 v90, 0
    v_mov_b32 v91, 0
    v_mov_b32 v92, 0
    v_mov_b32 v93, 0
    v_mov_b32 v94, 0
    v_mov_b32 v95, 0
    v_mov_b32 v96, 0
    v_mov_b32 v97, 0
    v_mov_b32 v98, 0
    v_mov_b32 v99, 0
    v_mov_b32 v100, 0
    v_mov_b32 v101, 0
    v_mov_b32 v102, 0
    v_mov_b32 v103, 0
    v_mov_b32 v104, 0
    v_mov_b32 v105, 0
    v_mov_b32 v106, 0
    v_mov_b32 v107, 0
    v_mov_b32 v108, 0
    v_mov_b32 v109, 0
    v_mov_b32 v110, 0
    v_mov_b32 v111, 0
    s_mov_b32 s59, 1
    s_setprio 1
    s_branch L_attn_entry
L_hw:
    s_waitcnt lgkmcnt(0)
    s_mov_b32 s24, s98
    s_mov_b32 s25, s99
    s_mov_b32 s26, 0x6f0000
    s_mov_b32 s27, 0x20000
    s_mov_b32 s28, s96
    s_mov_b32 s29, s97
    s_mov_b32 s30, 0x100
    s_mov_b32 s31, 0x20000
    s_sub_u32 s3, s3, 4
    s_lshl_b32 s48, s4, 1
    s_lshr_b32 s49, s3, 1
    s_add_u32 s48, s48, s49
    s_lshl_b32 s48, s48, 4
    s_lshl_b32 s49, s5, 1
    s_add_u32 s48, s48, s49
    s_and_b32 s49, s3, 1
    s_add_u32 s48, s48, s49
    s_lshl_b32 s48, s48, 11
    s_add_u32 s52, s48, 4718592
    s_add_u32 s3, s3, 4
    v_mov_b32 v232, -1
    v_mov_b32 v233, -1
    v_mov_b32 v234, -1
    v_mov_b32 v235, -1
    buffer_store_dwordx4 v[232:235], v2, s[24:27], s52 offen sc1
    buffer_store_dwordx4 v[232:235], v2, s[24:27], s52 offen offset:1024 sc1
    s_cmp_eq_u32 s5, 7
    s_cbranch_scc1 L_hw7
    s_cmp_eq_u32 s3, 4
    s_cbranch_scc0 L_nz_31
    v_lshlrev_b32 v12, 2, v1
    v_add_u32 v12, 159744, v12
    ds_write_b32 v12, v247
L_nz_31:
    v_and_b32 v12, 31, v1
    v_bfe_u32 v13, v12, 2, 1
    v_lshlrev_b32 v13, 4, v13
    v_lshrrev_b32 v14, 3, v12
    v_lshl_add_u32 v13, v14, 2, v13
    v_and_b32 v14, 3, v12
    v_add_u32 v13, v13, v14
    v_mov_b32 v30, v13
    s_sub_u32 s48, s3, 4
    s_lshr_b32 s48, s48, 1
    s_lshl_b32 s48, s48, 5
    v_add_u32 v13, s48, v13
    v_lshrrev_b32 v14, 5, v1
    v_lshrrev_b32 v15, 1, v13
    v_and_b32 v15, 7, v15
    v_lshlrev_b32 v12, 7, v13
    v_xor_b32 v15, v15, v14
    v_xor_b32 v11, 0, v15
    v_lshl_add_u32 v16, v11, 4, v12
    v_xor_b32 v11, 2, v15
    v_lshl_add_u32 v17, v11, 4, v12
    v_xor_b32 v11, 4, v15
    v_lshl_add_u32 v18, v11, 4, v12
    v_xor_b32 v11, 6, v15
    v_lshl_add_u32 v19, v11, 4, v12
    v_lshrrev_b32 v12, 5, v1
    v_mul_u32_u24 v12, 8, v12
    v_bfe_u32 v13, v1, 2, 2
    v_add_u32 v12, v12, v13
    v_mul_u32_u24 v12, 128, v12
    v_bfe_u32 v13, v1, 4, 1
    v_lshl_add_u32 v12, v13, 5, v12
    v_and_b32 v13, 3, v1
    v_lshl_add_u32 v28, v13, 3, v12
    s_and_b32 s48, s3, 1
    s_mul_i32 s48, s48, 56
    s_add_u32 s48, s48, 57344
    v_add_u32 v28, s48, v28
    v_add_u32 v29, 49152, v28
    s_and_b32 s48, s3, 1
    s_lshl_b32 s48, s48, 5
    s_lshl_b32 s49, s5, 6
    s_add_u32 s48, s48, s49
    v_and_b32 v12, 31, v1
    v_add_lshl_u32 v12, v12, s48, 1
    s_mov_b32 s36, s76
    s_mov_b32 s37, s77
    s_mov_b32 s38, 0x380
    s_mov_b32 s39, 0x20000
    buffer_load_ushort v208, v12, s[36:39], 0 offen
    s_mov_b32 s36, s78
    s_mov_b32 s37, s79
    s_mov_b32 s38, 0x380
    s_mov_b32 s39, 0x20000
    buffer_load_ushort v209, v12, s[36:39], 0 offen
    s_mov_b32 s36, s88
    s_mov_b32 s37, s89
    s_mov_b32 s38, 0x380
    s_mov_b32 s39, 0x20000
    buffer_load_ushort v210, v12, s[36:39], 0 offen
    s_mov_b32 s36, s90
    s_mov_b32 s37, s91
    s_mov_b32 s38, 0x380
    s_mov_b32 s39, 0x20000
    buffer_load_ushort v211, v12, s[36:39], 0 offen
    s_and_b32 s48, s3, 1
    s_lshl_b32 s48, s48, 5
    v_and_b32 v13, 31, v1
    v_add_u32 v13, s48, v13
    v_lshrrev_b32 v14, 5, v1
    v_lshrrev_b32 v15, 1, v13
    v_and_b32 v15, 7, v15
    v_lshlrev_b32 v12, 7, v13
    v_add_u32 v12, 65536, v12
    v_xor_b32 v15, v15, v14
    v_xor_b32 v11, 0, v15
    v_lshl_add_u32 v20, v11, 4, v12
    v_xor_b32 v11, 2, v15
    v_lshl_add_u32 v21, v11, 4, v12
    v_xor_b32 v11, 4, v15
    v_lshl_add_u32 v22, v11, 4, v12
    v_xor_b32 v11, 6, v15
    v_lshl_add_u32 v23, v11, 4, v12
    v_add_u32 v24, 49152, v20
    v_add_u32 v25, 49152, v21
    v_add_u32 v26, 49152, v22
    v_add_u32 v27, 49152, v23
    s_waitcnt lgkmcnt(0)
    s_barrier
    ds_read_b128 v[64:67], v16 offset:0
    ds_read_b64_tr_b16 v[112:113], v28 offset:0
    ds_read_b64_tr_b16 v[114:115], v28 offset:512
    ds_read_b128 v[80:83], v20 offset:0
    ds_read_b128 v[96:99], v20 offset:8192
    ds_read_b128 v[68:71], v17 offset:0
    ds_read_b64_tr_b16 v[116:117], v28 offset:2048
    ds_read_b64_tr_b16 v[118:119], v28 offset:2560
    ds_read_b128 v[84:87], v21 offset:0
    ds_read_b128 v[100:103], v21 offset:8192
    ds_read_b128 v[72:75], v18 offset:0
    ds_read_b64_tr_b16 v[120:121], v28 offset:4096
    ds_read_b64_tr_b16 v[122:123], v28 offset:4608
    ds_read_b128 v[88:91], v22 offset:0
    ds_read_b128 v[104:107], v22 offset:8192
    ds_read_b128 v[76:79], v19 offset:0
    ds_read_b64_tr_b16 v[124:125], v28 offset:6144
    ds_read_b64_tr_b16 v[126:127], v28 offset:6656
    ds_read_b128 v[92:95], v23 offset:0
    ds_read_b128 v[108:111], v23 offset:8192
    s_waitcnt lgkmcnt(0)
    s_barrier
    v_mfma_f32_32x32x16_bf16 v[32:47], v[64:67], v[80:83], 0
    ds_read_b128 v[128:131], v16 offset:8192
    ds_read_b64_tr_b16 v[176:177], v28 offset:24576
    v_mfma_f32_32x32x16_bf16 v[48:63], v[64:67], v[96:99], 0
    ds_read_b64_tr_b16 v[178:179], v28 offset:25088
    ds_read_b128 v[144:147], v20 offset:24576
    v_mfma_f32_32x32x16_bf16 v[192:207], v[112:115], v[64:67], 0
    ds_read_b128 v[160:163], v20 offset:32768
    ds_read_b128 v[132:135], v17 offset:8192
    v_mfma_f32_32x32x16_bf16 v[32:47], v[68:71], v[84:87], v[32:47]
    ds_read_b64_tr_b16 v[180:181], v28 offset:26624
    ds_read_b64_tr_b16 v[182:183], v28 offset:27136
    v_mfma_f32_32x32x16_bf16 v[48:63], v[68:71], v[100:103], v[48:63]
    ds_read_b128 v[148:151], v21 offset:24576
    ds_read_b128 v[164:167], v21 offset:32768
    v_mfma_f32_32x32x16_bf16 v[192:207], v[116:119], v[68:71], v[192:207]
    ds_read_b128 v[136:139], v18 offset:8192
    ds_read_b64_tr_b16 v[184:185], v28 offset:28672
    v_mfma_f32_32x32x16_bf16 v[32:47], v[72:75], v[88:91], v[32:47]
    ds_read_b64_tr_b16 v[186:187], v28 offset:29184
    ds_read_b128 v[152:155], v22 offset:24576
    v_mfma_f32_32x32x16_bf16 v[48:63], v[72:75], v[104:107], v[48:63]
    ds_read_b128 v[168:171], v22 offset:32768
    ds_read_b128 v[140:143], v19 offset:8192
    v_mfma_f32_32x32x16_bf16 v[192:207], v[120:123], v[72:75], v[192:207]
    ds_read_b64_tr_b16 v[188:189], v28 offset:30720
    ds_read_b64_tr_b16 v[190:191], v28 offset:31232
    v_mfma_f32_32x32x16_bf16 v[32:47], v[76:79], v[92:95], v[32:47]
    ds_read_b128 v[156:159], v23 offset:24576
    ds_read_b128 v[172:175], v23 offset:32768
    v_mfma_f32_32x32x16_bf16 v[48:63], v[76:79], v[108:111], v[48:63]
    v_mfma_f32_32x32x16_bf16 v[192:207], v[124:127], v[76:79], v[192:207]
    s_waitcnt vmcnt(0)
    v_lshlrev_b32 v208, 16, v208
    v_lshlrev_b32 v209, 16, v209
    v_lshlrev_b32 v210, 16, v210
    s_mov_b32 s48, 0x3fb8aa3b
    v_mul_f32 v210, s48, v210
    v_exp_f32 v210, v210
    s_nop 0
    v_cvt_pk_bf16_f32 v210, v210, v247
    v_lshlrev_b32 v210, 16, v210
    v_mul_f32 v224, v210, v208
    v_mul_f32 v225, v210, v209
    v_mul_f32 v224, s48, v224
    v_exp_f32 v224, v224
    v_mul_f32 v225, 0.15915494, v225
    v_fract_f32 v225, v225
    v_cos_f32 v226, v225
    v_sin_f32 v225, v225
    s_nop 0
    v_mul_f32 v212, v224, v226
    v_mul_f32 v213, v224, v225
    v_add_f32 v224, -1.0, v212
    v_mul_f32 v225, v208, v208
    v_fma_f32 v225, v209, v209, v225
    v_rcp_f32 v225, v225
    v_mul_f32 v226, v224, v208
    v_fma_f32 v226, v213, v209, v226
    v_mul_f32 v227, v213, v208
    v_fma_f32 v227, -v224, v209, v227
    v_mul_f32 v214, v226, v225
    v_mul_f32 v215, v227, v225
    v_lshlrev_b32 v9, 16, v211
    v_mul_f32 v9, 0.5, v9
    v_mov_b32 v8, v9
    v_mul_f32 v225, v213, v213
    v_fma_f32 v224, v212, v212, -v225
    v_mul_f32 v225, v212, v213
    v_add_f32 v225, v225, v225
    v_mul_f32 v227, v225, v225
    v_fma_f32 v226, v224, v224, -v227
    v_mul_f32 v227, v224, v225
    v_add_f32 v227, v227, v227
    v_mul_f32 v225, v227, v227
    v_fma_f32 v224, v226, v226, -v225
    v_mul_f32 v225, v226, v227
    v_add_f32 v225, v225, v225
    v_mul_f32 v217, v225, v225
    v_fma_f32 v216, v224, v224, -v217
    v_mul_f32 v217, v224, v225
    v_add_f32 v217, v217, v217
    v_mul_f32 v223, v217, v217
    v_fma_f32 v222, v216, v216, -v223
    v_mul_f32 v223, v216, v217
    v_add_f32 v223, v223, v223
    v_mul_f32 v219, v223, v223
    v_fma_f32 v218, v222, v222, -v219
    v_mul_f32 v219, v222, v223
    v_add_f32 v219, v219, v219
    v_mul_f32 v221, v219, v219
    v_fma_f32 v220, v218, v218, -v221
    v_mul_f32 v221, v218, v219
    v_add_f32 v221, v221, v221
    s_waitcnt lgkmcnt(0)
    s_barrier
    v_mfma_f32_32x32x16_bf16 v[32:47], v[128:131], v[144:147], v[32:47]
    ds_read_b128 v[64:67], v16 offset:16384
    ds_read_b64_tr_b16 v[112:113], v29 offset:0
    v_mfma_f32_32x32x16_bf16 v[48:63], v[128:131], v[160:163], v[48:63]
    ds_read_b64_tr_b16 v[114:115], v29 offset:512
    ds_read_b128 v[80:83], v24 offset:0
    v_mfma_f32_32x32x16_bf16 v[192:207], v[176:179], v[128:131], v[192:207]
    ds_read_b128 v[96:99], v24 offset:8192
    ds_read_b128 v[68:71], v17 offset:16384
    v_mfma_f32_32x32x16_bf16 v[32:47], v[132:135], v[148:151], v[32:47]
    ds_read_b64_tr_b16 v[116:117], v29 offset:2048
    ds_read_b64_tr_b16 v[118:119], v29 offset:2560
    v_mfma_f32_32x32x16_bf16 v[48:63], v[132:135], v[164:167], v[48:63]
    ds_read_b128 v[84:87], v25 offset:0
    ds_read_b128 v[100:103], v25 offset:8192
    v_mfma_f32_32x32x16_bf16 v[192:207], v[180:183], v[132:135], v[192:207]
    ds_read_b128 v[72:75], v18 offset:16384
    ds_read_b64_tr_b16 v[120:121], v29 offset:4096
    v_mfma_f32_32x32x16_bf16 v[32:47], v[136:139], v[152:155], v[32:47]
    ds_read_b64_tr_b16 v[122:123], v29 offset:4608
    ds_read_b128 v[88:91], v26 offset:0
    v_mfma_f32_32x32x16_bf16 v[48:63], v[136:139], v[168:171], v[48:63]
    ds_read_b128 v[104:107], v26 offset:8192
    ds_read_b128 v[76:79], v19 offset:16384
    v_mfma_f32_32x32x16_bf16 v[192:207], v[184:187], v[136:139], v[192:207]
    ds_read_b64_tr_b16 v[124:125], v29 offset:6144
    ds_read_b64_tr_b16 v[126:127], v29 offset:6656
    v_mfma_f32_32x32x16_bf16 v[32:47], v[140:143], v[156:159], v[32:47]
    ds_read_b128 v[92:95], v27 offset:0
    ds_read_b128 v[108:111], v27 offset:8192
    v_mfma_f32_32x32x16_bf16 v[48:63], v[140:143], v[172:175], v[48:63]
    v_mfma_f32_32x32x16_bf16 v[192:207], v[188:191], v[140:143], v[192:207]
    s_waitcnt lgkmcnt(0)
    s_barrier
    v_mfma_f32_32x32x16_bf16 v[32:47], v[64:67], v[80:83], v[32:47]
    ds_read_b128 v[128:131], v16 offset:24576
    ds_read_b64_tr_b16 v[176:177], v29 offset:24576
    v_mfma_f32_32x32x16_bf16 v[48:63], v[64:67], v[96:99], v[48:63]
    ds_read_b64_tr_b16 v[178:179], v29 offset:25088
    ds_read_b128 v[144:147], v24 offset:24576
    v_mfma_f32_32x32x16_bf16 v[192:207], v[112:115], v[64:67], v[192:207]
    ds_read_b128 v[160:163], v24 offset:32768
    ds_read_b128 v[132:135], v17 offset:24576
    v_mfma_f32_32x32x16_bf16 v[32:47], v[68:71], v[84:87], v[32:47]
    ds_read_b64_tr_b16 v[180:181], v29 offset:26624
    ds_read_b64_tr_b16 v[182:183], v29 offset:27136
    v_mfma_f32_32x32x16_bf16 v[48:63], v[68:71], v[100:103], v[48:63]
    ds_read_b128 v[148:151], v25 offset:24576
    ds_read_b128 v[164:167], v25 offset:32768
    v_mfma_f32_32x32x16_bf16 v[192:207], v[116:119], v[68:71], v[192:207]
    ds_read_b128 v[136:139], v18 offset:24576
    ds_read_b64_tr_b16 v[184:185], v29 offset:28672
    v_mfma_f32_32x32x16_bf16 v[32:47], v[72:75], v[88:91], v[32:47]
    ds_read_b64_tr_b16 v[186:187], v29 offset:29184
    ds_read_b128 v[152:155], v26 offset:24576
    v_mfma_f32_32x32x16_bf16 v[48:63], v[72:75], v[104:107], v[48:63]
    ds_read_b128 v[168:171], v26 offset:32768
    ds_read_b128 v[140:143], v19 offset:24576
    v_mfma_f32_32x32x16_bf16 v[192:207], v[120:123], v[72:75], v[192:207]
    ds_read_b64_tr_b16 v[188:189], v29 offset:30720
    ds_read_b64_tr_b16 v[190:191], v29 offset:31232
    v_mfma_f32_32x32x16_bf16 v[32:47], v[76:79], v[92:95], v[32:47]
    ds_read_b128 v[156:159], v27 offset:24576
    ds_read_b128 v[172:175], v27 offset:32768
    v_mfma_f32_32x32x16_bf16 v[48:63], v[76:79], v[108:111], v[48:63]
    v_mfma_f32_32x32x16_bf16 v[192:207], v[124:127], v[76:79], v[192:207]
    s_waitcnt lgkmcnt(0)
    s_barrier
    v_mfma_f32_32x32x16_bf16 v[32:47], v[128:131], v[144:147], v[32:47]
    ds_read_b128 v[64:67], v16 offset:32768
    ds_read_b64_tr_b16 v[112:113], v28 offset:0
    v_mfma_f32_32x32x16_bf16 v[48:63], v[128:131], v[160:163], v[48:63]
    ds_read_b64_tr_b16 v[114:115], v28 offset:512
    ds_read_b128 v[80:83], v20 offset:0
    v_mfma_f32_32x32x16_bf16 v[192:207], v[176:179], v[128:131], v[192:207]
    ds_read_b128 v[96:99], v20 offset:8192
    ds_read_b128 v[68:71], v17 offset:32768
    v_mfma_f32_32x32x16_bf16 v[32:47], v[132:135], v[148:151], v[32:47]
    ds_read_b64_tr_b16 v[116:117], v28 offset:2048
    ds_read_b64_tr_b16 v[118:119], v28 offset:2560
    v_mfma_f32_32x32x16_bf16 v[48:63], v[132:135], v[164:167], v[48:63]
    ds_read_b128 v[84:87], v21 offset:0
    ds_read_b128 v[100:103], v21 offset:8192
    v_mfma_f32_32x32x16_bf16 v[192:207], v[180:183], v[132:135], v[192:207]
    ds_read_b128 v[72:75], v18 offset:32768
    ds_read_b64_tr_b16 v[120:121], v28 offset:4096
    v_mfma_f32_32x32x16_bf16 v[32:47], v[136:139], v[152:155], v[32:47]
    ds_read_b64_tr_b16 v[122:123], v28 offset:4608
    ds_read_b128 v[88:91], v22 offset:0
    v_mfma_f32_32x32x16_bf16 v[48:63], v[136:139], v[168:171], v[48:63]
    ds_read_b128 v[104:107], v22 offset:8192
    ds_read_b128 v[76:79], v19 offset:32768
    v_mfma_f32_32x32x16_bf16 v[192:207], v[184:187], v[136:139], v[192:207]
    ds_read_b64_tr_b16 v[124:125], v28 offset:6144
    ds_read_b64_tr_b16 v[126:127], v28 offset:6656
    v_mfma_f32_32x32x16_bf16 v[32:47], v[140:143], v[156:159], v[32:47]
    ds_read_b128 v[92:95], v23 offset:0
    ds_read_b128 v[108:111], v23 offset:8192
    v_mfma_f32_32x32x16_bf16 v[48:63], v[140:143], v[172:175], v[48:63]
    v_mfma_f32_32x32x16_bf16 v[192:207], v[188:191], v[140:143], v[192:207]
    s_waitcnt lgkmcnt(0)
    s_barrier
    v_mfma_f32_32x32x16_bf16 v[32:47], v[64:67], v[80:83], v[32:47]
    ds_read_b128 v[128:131], v16 offset:40960
    ds_read_b64_tr_b16 v[176:177], v28 offset:24576
    v_mfma_f32_32x32x16_bf16 v[48:63], v[64:67], v[96:99], v[48:63]
    ds_read_b64_tr_b16 v[178:179], v28 offset:25088
    ds_read_b128 v[144:147], v20 offset:24576
    v_mfma_f32_32x32x16_bf16 v[192:207], v[112:115], v[64:67], v[192:207]
    ds_read_b128 v[160:163], v20 offset:32768
    ds_read_b128 v[132:135], v17 offset:40960
    v_mfma_f32_32x32x16_bf16 v[32:47], v[68:71], v[84:87], v[32:47]
    ds_read_b64_tr_b16 v[180:181], v28 offset:26624
    ds_read_b64_tr_b16 v[182:183], v28 offset:27136
    v_mfma_f32_32x32x16_bf16 v[48:63], v[68:71], v[100:103], v[48:63]
    ds_read_b128 v[148:151], v21 offset:24576
    ds_read_b128 v[164:167], v21 offset:32768
    v_mfma_f32_32x32x16_bf16 v[192:207], v[116:119], v[68:71], v[192:207]
    ds_read_b128 v[136:139], v18 offset:40960
    ds_read_b64_tr_b16 v[184:185], v28 offset:28672
    v_mfma_f32_32x32x16_bf16 v[32:47], v[72:75], v[88:91], v[32:47]
    ds_read_b64_tr_b16 v[186:187], v28 offset:29184
    ds_read_b128 v[152:155], v22 offset:24576
    v_mfma_f32_32x32x16_bf16 v[48:63], v[72:75], v[104:107], v[48:63]
    ds_read_b128 v[168:171], v22 offset:32768
    ds_read_b128 v[140:143], v19 offset:40960
    v_mfma_f32_32x32x16_bf16 v[192:207], v[120:123], v[72:75], v[192:207]
    ds_read_b64_tr_b16 v[188:189], v28 offset:30720
    ds_read_b64_tr_b16 v[190:191], v28 offset:31232
    v_mfma_f32_32x32x16_bf16 v[32:47], v[76:79], v[92:95], v[32:47]
    ds_read_b128 v[156:159], v23 offset:24576
    ds_read_b128 v[172:175], v23 offset:32768
    v_mfma_f32_32x32x16_bf16 v[48:63], v[76:79], v[108:111], v[48:63]
    v_mfma_f32_32x32x16_bf16 v[192:207], v[124:127], v[76:79], v[192:207]
    s_waitcnt lgkmcnt(0)
    s_barrier
    v_mfma_f32_32x32x16_bf16 v[32:47], v[128:131], v[144:147], v[32:47]
    ds_read_b128 v[64:67], v16 offset:49152
    ds_read_b64_tr_b16 v[112:113], v29 offset:0
    v_mfma_f32_32x32x16_bf16 v[48:63], v[128:131], v[160:163], v[48:63]
    ds_read_b64_tr_b16 v[114:115], v29 offset:512
    ds_read_b128 v[80:83], v24 offset:0
    v_mfma_f32_32x32x16_bf16 v[192:207], v[176:179], v[128:131], v[192:207]
    ds_read_b128 v[96:99], v24 offset:8192
    ds_read_b128 v[68:71], v17 offset:49152
    v_mfma_f32_32x32x16_bf16 v[32:47], v[132:135], v[148:151], v[32:47]
    ds_read_b64_tr_b16 v[116:117], v29 offset:2048
    ds_read_b64_tr_b16 v[118:119], v29 offset:2560
    v_mfma_f32_32x32x16_bf16 v[48:63], v[132:135], v[164:167], v[48:63]
    ds_read_b128 v[84:87], v25 offset:0
    ds_read_b128 v[100:103], v25 offset:8192
    v_mfma_f32_32x32x16_bf16 v[192:207], v[180:183], v[132:135], v[192:207]
    ds_read_b128 v[72:75], v18 offset:49152
    ds_read_b64_tr_b16 v[120:121], v29 offset:4096
    v_mfma_f32_32x32x16_bf16 v[32:47], v[136:139], v[152:155], v[32:47]
    ds_read_b64_tr_b16 v[122:123], v29 offset:4608
    ds_read_b128 v[88:91], v26 offset:0
    v_mfma_f32_32x32x16_bf16 v[48:63], v[136:139], v[168:171], v[48:63]
    ds_read_b128 v[104:107], v26 offset:8192
    ds_read_b128 v[76:79], v19 offset:49152
    v_mfma_f32_32x32x16_bf16 v[192:207], v[184:187], v[136:139], v[192:207]
    ds_read_b64_tr_b16 v[124:125], v29 offset:6144
    ds_read_b64_tr_b16 v[126:127], v29 offset:6656
    v_mfma_f32_32x32x16_bf16 v[32:47], v[140:143], v[156:159], v[32:47]
    ds_read_b128 v[92:95], v27 offset:0
    ds_read_b128 v[108:111], v27 offset:8192
    v_mfma_f32_32x32x16_bf16 v[48:63], v[140:143], v[172:175], v[48:63]
    v_mfma_f32_32x32x16_bf16 v[192:207], v[188:191], v[140:143], v[192:207]
    s_cmp_ge_u32 s3, 6
    s_cselect_b32 s36, s86, s84
    s_cselect_b32 s37, s87, s85
    s_mov_b32 s38, 0x62000
    s_mov_b32 s39, 0x20000
    s_and_b32 s48, s4, 7
    s_lshl_b32 s48, s48, 1
    s_and_b32 s49, s3, 1
    s_add_u32 s48, s48, s49
    s_mul_i32 s48, s48, 3584
    s_mul_i32 s49, s5, 57344
    s_add_u32 s48, s48, s49
    v_lshlrev_b32 v12, 7, v1
    s_mov_b32 exec_lo, 0xfffffff
    s_mov_b32 exec_hi, 0
    buffer_load_dword v240, v12, s[36:39], s48 offen
    s_mov_b64 exec, -1
    s_waitcnt lgkmcnt(0)
    v_mfma_f32_32x32x16_bf16 v[192:207], v[112:115], v[64:67], v[192:207]
    v_mfma_f32_32x32x16_bf16 v[192:207], v[116:119], v[68:71], v[192:207]
    v_mfma_f32_32x32x16_bf16 v[192:207], v[120:123], v[72:75], v[192:207]
    v_mfma_f32_32x32x16_bf16 v[192:207], v[124:127], v[76:79], v[192:207]
    v_mfma_f32_32x32x16_bf16 v[32:47], v[64:67], v[80:83], v[32:47]
    v_mfma_f32_32x32x16_bf16 v[48:63], v[64:67], v[96:99], v[48:63]
    v_mfma_f32_32x32x16_bf16 v[32:47], v[68:71], v[84:87], v[32:47]
    s_nop 7
    s_nop 0
    v_mfma_f32_32x32x16_bf16 v[48:63], v[68:71], v[100:103], v[48:63]
    s_mov_b32 s48, 0x3e8b97f6
    v_mov_b32 v236, v204
    v_mul_f32 v192, s48, v192
    v_mul_f32 v193, s48, v193
    v_mul_f32 v194, s48, v194
    v_mul_f32 v195, s48, v195
    v_mul_f32 v196, s48, v196
    v_mul_f32 v197, s48, v197
    v_mul_f32 v198, s48, v198
    v_mul_f32 v199, s48, v199
    v_mul_f32 v200, s48, v200
    v_mul_f32 v201, s48, v201
    v_mfma_f32_32x32x16_bf16 v[32:47], v[72:75], v[88:91], v[32:47]
    v_mul_f32 v202, s48, v202
    v_mul_f32 v203, s48, v203
    v_mul_f32 v204, s48, v204
    v_mul_f32 v205, s48, v205
    v_mul_f32 v206, s48, v206
    v_mul_f32 v207, s48, v207
    v_cvt_pk_bf16_f32 v224, v192, v193
    v_cvt_pk_bf16_f32 v225, v194, v195
    v_cvt_pk_bf16_f32 v226, v196, v197
    v_cvt_pk_bf16_f32 v227, v198, v199
    v_cvt_pk_bf16_f32 v228, v200, v201
    v_cvt_pk_bf16_f32 v229, v202, v203
    v_mfma_f32_32x32x16_bf16 v[48:63], v[72:75], v[104:107], v[48:63]
    v_cvt_pk_bf16_f32 v230, v204, v205
    v_cvt_pk_bf16_f32 v231, v206, v207
    v_cndmask_b32 v230, v230, v247, s[46:47]
    v_cndmask_b32 v231, v231, v247, s[46:47]
    s_sub_u32 s48, s3, 4
    s_lshl_b32 s48, s48, 11
    s_add_u32 s48, s48, 57344
    v_add_u32 v12, s48, v2
    ds_write_b128 v12, v[224:227]
    s_mov_b32 s50, 0xbfb8aa3b
    v_mul_f32 v236, s50, v236
    v_exp_f32 v236, v236
    v_mfma_f32_32x32x16_bf16 v[32:47], v[76:79], v[92:95], v[32:47]
    v_dot2_f32_bf16 v232, v224, v224, v247
    v_dot2_f32_bf16 v233, v225, v225, v247
    v_dot2_f32_bf16 v232, v226, v226, v232
    v_dot2_f32_bf16 v233, v227, v227, v233
    v_dot2_f32_bf16 v232, v228, v228, v232
    v_dot2_f32_bf16 v233, v229, v229, v233
    v_dot2_f32_bf16 v232, v230, v230, v232
    v_dot2_f32_bf16 v233, v231, v231, v233
    s_nop 2
    v_add_f32 v232, v232, v233
    v_mov_b32 v233, v232
    s_nop 1
    v_mfma_f32_32x32x16_bf16 v[48:63], v[76:79], v[108:111], v[48:63]
    v_permlane32_swap_b32 v232, v233
    s_nop 1
    v_add_f32 v232, v232, v233
    v_add_f32 v236, 1.0, v236
    v_sqrt_f32 v232, v232
    v_rcp_f32 v236, v236
    s_mov_b32 s48, 0x3f820000
    v_mul_f32 v232, s48, v232
    v_cvt_pk_bf16_f32 v234, v232, v247
    v_cndmask_b32 v230, v230, v234, s[46:47]
    ds_write_b128 v12, v[228:231] offset:1024
    s_bitcmp1_b32 s3, 0
    s_cbranch_scc0 L_nog_32
    s_sub_u32 s48, s3, 4
    s_lshr_b32 s48, s48, 1
    s_lshl_b32 s48, s48, 7
    s_add_u32 s48, s48, 155648
    v_lshlrev_b32 v13, 2, v30
    v_add_u32 v13, s48, v13
    s_mov_b64 exec, s[46:47]
    ds_write_b32 v13, v236
    s_mov_b64 exec, -1
L_nog_32:
    s_waitcnt lgkmcnt(0)
    v_mov_b32 v12, 159820
    v_mov_b32 v13, 1
    s_mov_b64 exec, 1
    ds_add_u32 v12, v13
    s_mov_b64 exec, -1
    s_barrier
    s_sub_u32 s61, s3, 4
    s_lshr_b32 s62, s61, 1
    s_and_b32 s63, s61, 1
    s_lshl_b32 s48, s62, 7
    s_add_u32 s48, s48, 155648
    v_lshrrev_b32 v14, 5, v1
    v_lshlrev_b32 v13, 6, v14
    v_add_u32 v13, s48, v13
    ds_read_b128 v[192:195], v13 offset:0
    ds_read_b128 v[196:199], v13 offset:16
    ds_read_b128 v[200:203], v13 offset:32
    ds_read_b128 v[204:207], v13 offset:48
    v_and_b32 v12, 31, v1
    v_lshrrev_b32 v13, 3, v12
    v_and_b32 v12, 7, v1
    v_lshlrev_b32 v12, 1, v12
    v_lshl_add_u32 v12, v14, 11, v12
    s_add_u32 s49, s5, 7
    s_sub_u32 s49, s49, s22
    s_cmp_ge_u32 s49, 7
    s_cselect_b32 s48, 7, 0
    s_sub_u32 s49, s49, s48
    s_lshl_b32 s48, s62, 12
    s_lshl_b32 s49, s49, 13
    s_add_u32 s48, s48, s49
    s_lshl_b32 s49, s63, 6
    s_add_u32 s48, s48, s49
    v_add_u32 v12, s48, v12
    v_xor_b32 v15, 0, v13
    v_lshl_add_u32 v72, v15, 4, v12
    v_xor_b32 v76, 64, v72
    v_xor_b32 v15, 1, v13
    v_lshl_add_u32 v73, v15, 4, v12
    v_xor_b32 v77, 64, v73
    v_xor_b32 v15, 2, v13
    v_lshl_add_u32 v74, v15, 4, v12
    v_xor_b32 v78, 64, v74
    v_xor_b32 v15, 3, v13
    v_lshl_add_u32 v75, v15, 4, v12
    v_xor_b32 v79, 64, v75
    ds_read_u16 v224, v72 offset:0
    ds_read_u16 v225, v72 offset:128
    ds_read_u16 v226, v73 offset:256
    ds_read_u16 v227, v73 offset:384
    ds_read_u16 v228, v74 offset:512
    ds_read_u16 v229, v74 offset:640
    ds_read_u16 v230, v75 offset:768
    ds_read_u16 v231, v75 offset:896
    ds_read_u16 v232, v76 offset:1024
    ds_read_u16 v233, v76 offset:1152
    ds_read_u16 v234, v77 offset:1280
    ds_read_u16 v235, v77 offset:1408
    ds_read_u16 v236, v78 offset:1536
    ds_read_u16 v237, v78 offset:1664
    ds_read_u16 v238, v79 offset:1792
    ds_read_u16 v239, v79 offset:1920
    s_setprio 3
    s_nop 7
    s_nop 5
    v_mul_f32 v12, v215, v48
    v_mul_f32 v13, v215, v32
    v_fma_f32 v32, v214, v32, -v12
    v_fma_f32 v48, v214, v48, v13
    v_mul_f32 v12, v215, v49
    v_mul_f32 v13, v215, v33
    v_fma_f32 v33, v214, v33, -v12
    v_fma_f32 v49, v214, v49, v13
    v_mul_f32 v12, v215, v50
    v_mul_f32 v13, v215, v34
    v_fma_f32 v34, v214, v34, -v12
    v_fma_f32 v50, v214, v50, v13
    v_mul_f32 v12, v215, v51
    v_mul_f32 v13, v215, v35
    v_fma_f32 v35, v214, v35, -v12
    v_fma_f32 v51, v214, v51, v13
    v_mul_f32 v12, v215, v52
    v_mul_f32 v13, v215, v36
    v_fma_f32 v36, v214, v36, -v12
    v_fma_f32 v52, v214, v52, v13
    v_mul_f32 v12, v215, v53
    v_mul_f32 v13, v215, v37
    v_fma_f32 v37, v214, v37, -v12
    v_fma_f32 v53, v214, v53, v13
    v_mul_f32 v12, v215, v54
    v_mul_f32 v13, v215, v38
    v_fma_f32 v38, v214, v38, -v12
    v_fma_f32 v54, v214, v54, v13
    v_mul_f32 v12, v215, v55
    v_mul_f32 v13, v215, v39
    v_fma_f32 v39, v214, v39, -v12
    v_fma_f32 v55, v214, v55, v13
    v_mul_f32 v12, v215, v56
    v_mul_f32 v13, v215, v40
    v_fma_f32 v40, v214, v40, -v12
    v_fma_f32 v56, v214, v56, v13
    v_mul_f32 v12, v215, v57
    v_mul_f32 v13, v215, v41
    v_fma_f32 v41, v214, v41, -v12
    v_fma_f32 v57, v214, v57, v13
    v_mul_f32 v12, v215, v58
    v_mul_f32 v13, v215, v42
    v_fma_f32 v42, v214, v42, -v12
    v_fma_f32 v58, v214, v58, v13
    v_mul_f32 v12, v215, v59
    v_mul_f32 v13, v215, v43
    v_fma_f32 v43, v214, v43, -v12
    v_fma_f32 v59, v214, v59, v13
    v_mul_f32 v12, v215, v60
    v_mul_f32 v13, v215, v44
    v_fma_f32 v44, v214, v44, -v12
    v_fma_f32 v60, v214, v60, v13
    v_mul_f32 v12, v215, v61
    v_mul_f32 v13, v215, v45
    v_fma_f32 v45, v214, v45, -v12
    v_fma_f32 v61, v214, v61, v13
    v_mul_f32 v12, v215, v62
    v_mul_f32 v13, v215, v46
    v_fma_f32 v46, v214, v46, -v12
    v_fma_f32 v62, v214, v62, v13
    v_mul_f32 v12, v215, v63
    v_mul_f32 v13, v215, v47
    v_fma_f32 v47, v214, v47, -v12
    v_fma_f32 v63, v214, v63, v13
    v_mov_b32 v12, v32
    v_mov_b32 v13, v48
    v_fma_f32 v10, v212, v12, v33
    v_fma_f32 v11, v212, v13, v49
    v_fma_f32 v10, -v213, v13, v10
    v_fma_f32 v11, v213, v12, v11
    v_fma_f32 v12, v212, v10, v34
    v_fma_f32 v13, v212, v11, v50
    v_fma_f32 v12, -v213, v11, v12
    v_fma_f32 v13, v213, v10, v13
    v_fma_f32 v10, v212, v12, v35
    v_fma_f32 v11, v212, v13, v51
    v_fma_f32 v10, -v213, v13, v10
    v_fma_f32 v11, v213, v12, v11
    v_fma_f32 v12, v212, v10, v36
    v_fma_f32 v13, v212, v11, v52
    v_fma_f32 v12, -v213, v11, v12
    v_fma_f32 v13, v213, v10, v13
    v_fma_f32 v10, v212, v12, v37
    v_fma_f32 v11, v212, v13, v53
    v_fma_f32 v10, -v213, v13, v10
    v_fma_f32 v11, v213, v12, v11
    v_fma_f32 v12, v212, v10, v38
    v_fma_f32 v13, v212, v11, v54
    v_fma_f32 v12, -v213, v11, v12
    v_fma_f32 v13, v213, v10, v13
    v_fma_f32 v10, v212, v12, v39
    v_fma_f32 v11, v212, v13, v55
    v_fma_f32 v10, -v213, v13, v10
    v_fma_f32 v11, v213, v12, v11
    v_fma_f32 v12, v212, v10, v40
    v_fma_f32 v13, v212, v11, v56
    v_fma_f32 v12, -v213, v11, v12
    v_fma_f32 v13, v213, v10, v13
    v_fma_f32 v10, v212, v12, v41
    v_fma_f32 v11, v212, v13, v57
    v_fma_f32 v10, -v213, v13, v10
    v_fma_f32 v11, v213, v12, v11
    v_fma_f32 v12, v212, v10, v42
    v_fma_f32 v13, v212, v11, v58
    v_fma_f32 v12, -v213, v11, v12
    v_fma_f32 v13, v213, v10, v13
    v_fma_f32 v10, v212, v12, v43
    v_fma_f32 v11, v212, v13, v59
    v_fma_f32 v10, -v213, v13, v10
    v_fma_f32 v11, v213, v12, v11
    v_fma_f32 v12, v212, v10, v44
    v_fma_f32 v13, v212, v11, v60
    v_fma_f32 v12, -v213, v11, v12
    v_fma_f32 v13, v213, v10, v13
    v_fma_f32 v10, v212, v12, v45
    v_fma_f32 v11, v212, v13, v61
    v_fma_f32 v10, -v213, v13, v10
    v_fma_f32 v11, v213, v12, v11
    v_fma_f32 v12, v212, v10, v46
    v_fma_f32 v13, v212, v11, v62
    v_fma_f32 v12, -v213, v11, v12
    v_fma_f32 v13, v213, v10, v13
    v_fma_f32 v10, v212, v12, v47
    v_fma_f32 v11, v212, v13, v63
    v_fma_f32 v10, -v213, v13, v10
    v_fma_f32 v11, v213, v12, v11
    v_mov_b32 v12, v10
    v_mov_b32 v13, v11
    s_sub_u32 s48, s3, 4
    s_lshr_b32 s49, s48, 1
    s_and_b32 s48, s48, 1
    s_lshl_b32 s49, s49, 10
    s_lshl_b32 s48, s48, 8
    s_add_u32 s48, s48, s49
    s_add_u32 s48, s48, 156160
    v_lshrrev_b32 v14, 5, v1
    v_lshlrev_b32 v14, 9, v14
    v_and_b32 v15, 31, v1
    v_lshl_add_u32 v14, v15, 3, v14
    v_add_u32 v14, s48, v14
    ds_write_b64 v14, v[12:13]
    s_waitcnt lgkmcnt(0)
    v_mov_b32 v12, 159776
    v_mov_b32 v13, 1
    s_mov_b64 exec, 1
    ds_add_u32 v12, v13
    s_mov_b64 exec, -1
    v_mov_b32 v12, 159776
    s_mov_b32 s48, 0x400000
L_lw_33:
    ds_read_b32 v13, v12
    s_waitcnt lgkmcnt(0)
    v_readfirstlane_b32 s49, v13
    s_sub_u32 s48, s48, 1
    s_cbranch_scc1 L_lwd_34
    s_cmp_ge_u32 s49, 4
    s_cbranch_scc1 L_lwd_34
    s_branch L_lw_33
L_lwd_34:
    s_lshl_b32 s48, s63, 8
    s_add_u32 s48, s48, 156160
    v_and_b32 v13, 31, v1
    v_lshlrev_b32 v13, 3, v13
    v_add_u32 v13, s48, v13
    ds_read_b64 v[64:65], v13 offset:0
    ds_read_b64 v[66:67], v13 offset:512
    ds_read_b64 v[68:69], v13 offset:1024
    ds_read_b64 v[70:71], v13 offset:1536
    s_waitcnt lgkmcnt(0)
    v_fma_f32 v72, v64, v216, v66
    v_fma_f32 v73, v65, v216, v67
    v_fma_f32 v72, -v65, v217, v72
    v_fma_f32 v73, v64, v217, v73
    v_fma_f32 v74, v72, v216, v68
    v_fma_f32 v75, v73, v216, v69
    v_fma_f32 v74, -v73, v217, v74
    v_fma_f32 v75, v72, v217, v75
    v_fma_f32 v80, v74, v216, v70
    v_fma_f32 v81, v75, v216, v71
    v_fma_f32 v80, -v75, v217, v80
    v_fma_f32 v81, v74, v217, v81
    v_mov_b32 v12, 159232
    ds_read_b32 v13, v12
    s_waitcnt lgkmcnt(0)
    v_readfirstlane_b32 s6, v13
    s_nop 1
    v_mov_b32 v82, s6
    v_mov_b32 v83, s6
    v_mov_b32 v94, v80
    v_mov_b32 v95, v81
    s_lshl_b32 s54, s5, 10
    s_lshl_b32 s49, s63, 9
    s_add_u32 s54, s54, s49
    s_mov_b32 exec_hi, 0
    s_cmp_eq_u32 s62, 0
    s_cbranch_scc0 L_z0_36
    s_add_u32 s48, s4, 1
    s_mul_i32 s48, s48, 7168
    s_add_u32 s48, s48, s54
    s_add_u32 s48, s48, 262144
    buffer_store_dwordx4 v[80:83], v2, s[24:27], s48 offen sc1
    s_branch L_noE_35
L_z0_36:
    s_cmp_eq_u32 s4, 0
    s_cbranch_scc0 L_noE_35
    v_mov_b32 v80, 0
    v_mov_b32 v81, 0
    s_add_u32 s48, s54, 589824
    buffer_store_dwordx4 v[80:83], v2, s[24:27], s48 offen sc1
L_noE_35:
    s_mov_b64 exec, -1
    s_cmp_eq_u32 s62, 0
    s_cbranch_scc0 L_rt1_37
    v_cndmask_b32 v76, v247, v64, s[46:47]
    v_cndmask_b32 v77, v247, v65, s[46:47]
    v_mov_b32 v12, 1.0
    v_cndmask_b32 v78, v12, v216, s[46:47]
    v_cndmask_b32 v79, v247, v217, s[46:47]
    s_branch L_rtd_38
L_rt1_37:
    v_cndmask_b32 v76, v72, v74, s[46:47]
    v_cndmask_b32 v77, v73, v75, s[46:47]
    v_mul_f32 v12, v222, v216
    v_fma_f32 v12, -v223, v217, v12
    v_mul_f32 v13, v222, v217
    v_fma_f32 v13, v223, v216, v13
    v_cndmask_b32 v78, v222, v12, s[46:47]
    v_cndmask_b32 v79, v223, v13, s[46:47]
L_rtd_38:
    v_and_b32 v12, 31, v1
    v_lshrrev_b32 v13, 3, v12
    v_and_b32 v14, 7, v1
    v_lshlrev_b32 v14, 1, v14
    v_lshrrev_b32 v15, 5, v1
    v_lshl_add_u32 v14, v15, 11, v14
    s_lshl_b32 s55, s61, 12
    s_add_u32 s55, s55, 114688
    v_add_u32 v14, s55, v14
    v_xor_b32 v15, 0, v13
    v_lshl_add_u32 v86, v15, 4, v14
    v_xor_b32 v15, 1, v13
    v_lshl_add_u32 v87, v15, 4, v14
    v_xor_b32 v15, 2, v13
    v_lshl_add_u32 v88, v15, 4, v14
    v_xor_b32 v15, 3, v13
    v_lshl_add_u32 v89, v15, 4, v14
    v_mov_b32 v13, v30
    v_lshrrev_b32 v14, 5, v1
    v_lshrrev_b32 v15, 1, v13
    v_and_b32 v15, 7, v15
    v_lshlrev_b32 v12, 7, v13
    v_add_u32 v12, s55, v12
    v_xor_b32 v15, v15, v14
    v_xor_b32 v11, 0, v15
    v_lshl_add_u32 v90, v11, 4, v12
    v_xor_b32 v11, 2, v15
    v_lshl_add_u32 v91, v11, 4, v12
    v_xor_b32 v11, 4, v15
    v_lshl_add_u32 v92, v11, 4, v12
    v_xor_b32 v11, 6, v15
    v_lshl_add_u32 v93, v11, 4, v12
    v_mov_b32 v12, 159784
    s_mov_b32 s48, 0x400000
L_lw_39:
    ds_read_b32 v13, v12
    s_waitcnt lgkmcnt(0)
    v_readfirstlane_b32 s49, v13
    s_sub_u32 s48, s48, 1
    s_cbranch_scc1 L_lwd_40
    s_cmp_ge_u32 s49, 4
    s_cbranch_scc1 L_lwd_40
    s_branch L_lw_39
L_lwd_40:
    s_add_u32 s52, s61, 0
    s_and_b32 s51, s52, 1
    s_lshr_b32 s52, s52, 1
    s_cmp_ge_u32 s52, 7
    s_cselect_b32 s32, s86, s84
    s_cselect_b32 s33, s87, s85
    s_cselect_b32 s53, 7, 0
    s_mov_b32 s34, 0x62000
    s_mov_b32 s35, 0x20000
    s_sub_u32 s53, s52, s53
    s_lshl_b32 s53, s53, 7
    s_mul_i32 s48, s5, 57344
    s_add_u32 s53, s53, s48
    s_mul_i32 s48, s51, 28672
    s_add_u32 s53, s53, s48
    s_lshl_b32 s52, s52, 13
    s_lshl_b32 s51, s51, 12
    s_add_u32 m0, s52, s51
    s_nop 0
    buffer_load_dwordx4 v4, s[32:35], s53 offen offset:0 lds
    buffer_load_dwordx4 v5, s[32:35], s53 offen offset:1024 lds
    buffer_load_dwordx4 v6, s[32:35], s53 offen offset:2048 lds
    buffer_load_dwordx4 v7, s[32:35], s53 offen offset:3072 lds
    s_add_u32 s52, s61, 4
    s_and_b32 s51, s52, 1
    s_lshr_b32 s52, s52, 1
    s_cmp_ge_u32 s52, 7
    s_cselect_b32 s32, s86, s84
    s_cselect_b32 s33, s87, s85
    s_cselect_b32 s53, 7, 0
    s_mov_b32 s34, 0x62000
    s_mov_b32 s35, 0x20000
    s_sub_u32 s53, s52, s53
    s_lshl_b32 s53, s53, 7
    s_mul_i32 s48, s5, 57344
    s_add_u32 s53, s53, s48
    s_mul_i32 s48, s51, 28672
    s_add_u32 s53, s53, s48
    s_lshl_b32 s52, s52, 13
    s_lshl_b32 s51, s51, 12
    s_add_u32 m0, s52, s51
    s_nop 0
    buffer_load_dwordx4 v4, s[32:35], s53 offen offset:0 lds
    buffer_load_dwordx4 v5, s[32:35], s53 offen offset:1024 lds
    buffer_load_dwordx4 v6, s[32:35], s53 offen offset:2048 lds
    buffer_load_dwordx4 v7, s[32:35], s53 offen offset:3072 lds
    s_add_u32 s52, s61, 8
    s_and_b32 s51, s52, 1
    s_lshr_b32 s52, s52, 1
    s_cmp_ge_u32 s52, 7
    s_cselect_b32 s32, s86, s84
    s_cselect_b32 s33, s87, s85
    s_cselect_b32 s53, 7, 0
    s_mov_b32 s34, 0x62000
    s_mov_b32 s35, 0x20000
    s_sub_u32 s53, s52, s53
    s_lshl_b32 s53, s53, 7
    s_mul_i32 s48, s5, 57344
    s_add_u32 s53, s53, s48
    s_mul_i32 s48, s51, 28672
    s_add_u32 s53, s53, s48
    s_lshl_b32 s52, s52, 13
    s_lshl_b32 s51, s51, 12
    s_add_u32 m0, s52, s51
    s_nop 0
    buffer_load_dwordx4 v4, s[32:35], s53 offen offset:0 lds
    buffer_load_dwordx4 v5, s[32:35], s53 offen offset:1024 lds
    buffer_load_dwordx4 v6, s[32:35], s53 offen offset:2048 lds
    buffer_load_dwordx4 v7, s[32:35], s53 offen offset:3072 lds
    s_add_u32 s52, s61, 12
    s_and_b32 s51, s52, 1
    s_lshr_b32 s52, s52, 1
    s_cmp_ge_u32 s52, 7
    s_cselect_b32 s32, s86, s84
    s_cselect_b32 s33, s87, s85
    s_cselect_b32 s53, 7, 0
    s_mov_b32 s34, 0x62000
    s_mov_b32 s35, 0x20000
    s_sub_u32 s53, s52, s53
    s_lshl_b32 s53, s53, 7
    s_mul_i32 s48, s5, 57344
    s_add_u32 s53, s53, s48
    s_mul_i32 s48, s51, 28672
    s_add_u32 s53, s53, s48
    s_lshl_b32 s52, s52, 13
    s_lshl_b32 s51, s51, 12
    s_add_u32 m0, s52, s51
    s_nop 0
    buffer_load_dwordx4 v4, s[32:35], s53 offen offset:0 lds
    buffer_load_dwordx4 v5, s[32:35], s53 offen offset:1024 lds
    buffer_load_dwordx4 v6, s[32:35], s53 offen offset:2048 lds
    buffer_load_dwordx4 v7, s[32:35], s53 offen offset:3072 lds
    s_and_b32 s56, s4, 3
    s_lshr_b32 s57, s4, 2
    v_mov_b32 v80, 0
    v_mov_b32 v81, 0
    v_and_b32 v12, 31, v1
    v_lshlrev_b32 v82, 4, v12
    s_cmp_eq_u32 s62, 0
    s_cbranch_scc0 L_p1d_41
    s_cmp_eq_u32 s56, 0
    s_cbranch_scc1 L_p1d_41
    s_lshl_b32 s55, s57, 2
    s_add_u32 s55, s55, 1
    s_mul_i32 s55, s55, 7168
    s_add_u32 s55, s55, s54
    s_add_u32 s55, s55, 262144
    s_mov_b32 s58, 0x40000
L_p1_42:
    s_mov_b32 s48, s55
    buffer_load_dwordx4 v[128:131], v82, s[24:27], s48 offen sc1
    s_add_u32 s48, s48, 7168
    s_cmp_le_u32 s56, 1
    s_cbranch_scc1 L_p1l_43
    buffer_load_dwordx4 v[132:135], v82, s[24:27], s48 offen sc1
    s_add_u32 s48, s48, 7168
    s_cmp_le_u32 s56, 2
    s_cbranch_scc1 L_p1l_43
    buffer_load_dwordx4 v[136:139], v82, s[24:27], s48 offen sc1
    s_add_u32 s48, s48, 7168
L_p1l_43:
    s_waitcnt vmcnt(0)
    v_xor_b32 v83, s6, v130
    s_cmp_le_u32 s56, 1
    s_cbranch_scc1 L_p1c_44
    v_xor_b32 v84, s6, v134
    v_or_b32 v83, v83, v84
    s_cmp_le_u32 s56, 2
    s_cbranch_scc1 L_p1c_44
    v_xor_b32 v84, s6, v138
    v_or_b32 v83, v83, v84
L_p1c_44:
    v_cmp_ne_u32 vcc, 0, v83
    s_sub_u32 s58, s58, 1
    s_cbranch_scc1 L_p1o_45
    s_nop 2
    s_cbranch_vccz L_p1o_45
    s_sleep 10
    s_branch L_p1_42
L_p1o_45:
    v_mov_b32 v80, v128
    v_mov_b32 v81, v129
    s_cmp_le_u32 s56, 1
    s_cbranch_scc1 L_p1d_41
    v_fma_f32 v84, v218, v80, v132
    v_fma_f32 v85, v218, v81, v133
    v_fma_f32 v84, -v219, v81, v84
    v_fma_f32 v81, v219, v80, v85
    v_mov_b32 v80, v84
    s_cmp_le_u32 s56, 2
    s_cbranch_scc1 L_p1d_41
    v_fma_f32 v84, v218, v80, v136
    v_fma_f32 v85, v218, v81, v137
    v_fma_f32 v84, -v219, v81, v84
    v_fma_f32 v81, v219, v80, v85
    v_mov_b32 v80, v84
L_p1d_41:
    s_cmp_eq_u32 s56, 3
    s_cbranch_scc0 L_noG_46
    s_cmp_eq_u32 s62, 0
    s_cbranch_scc0 L_noG_46
    v_fma_f32 v128, v80, v218, v94
    v_fma_f32 v129, v81, v218, v95
    v_fma_f32 v128, -v81, v219, v128
    v_fma_f32 v129, v80, v219, v129
    v_mov_b32 v130, s6
    v_mov_b32 v131, s6
    s_add_u32 s48, s57, 1
    s_mul_i32 s48, s48, 7168
    s_add_u32 s48, s48, s54
    s_add_u32 s48, s48, 589824
    s_mov_b32 exec_hi, 0
    buffer_store_dwordx4 v[128:131], v2, s[24:27], s48 offen sc1
    s_mov_b64 exec, -1
L_noG_46:
    s_add_u32 s52, s61, 16
    s_and_b32 s51, s52, 1
    s_lshr_b32 s52, s52, 1
    s_cmp_ge_u32 s52, 7
    s_cselect_b32 s32, s86, s84
    s_cselect_b32 s33, s87, s85
    s_cselect_b32 s53, 7, 0
    s_mov_b32 s34, 0x62000
    s_mov_b32 s35, 0x20000
    s_sub_u32 s53, s52, s53
    s_lshl_b32 s53, s53, 7
    s_mul_i32 s48, s5, 57344
    s_add_u32 s53, s53, s48
    s_mul_i32 s48, s51, 28672
    s_add_u32 s53, s53, s48
    s_lshl_b32 s52, s52, 13
    s_lshl_b32 s51, s51, 12
    s_add_u32 m0, s52, s51
    s_nop 0
    buffer_load_dwordx4 v4, s[32:35], s53 offen offset:0 lds
    buffer_load_dwordx4 v5, s[32:35], s53 offen offset:1024 lds
    buffer_load_dwordx4 v6, s[32:35], s53 offen offset:2048 lds
    buffer_load_dwordx4 v7, s[32:35], s53 offen offset:3072 lds
    s_add_u32 s52, s61, 20
    s_and_b32 s51, s52, 1
    s_lshr_b32 s52, s52, 1
    s_cmp_ge_u32 s52, 7
    s_cselect_b32 s32, s86, s84
    s_cselect_b32 s33, s87, s85
    s_cselect_b32 s53, 7, 0
    s_mov_b32 s34, 0x62000
    s_mov_b32 s35, 0x20000
    s_sub_u32 s53, s52, s53
    s_lshl_b32 s53, s53, 7
    s_mul_i32 s48, s5, 57344
    s_add_u32 s53, s53, s48
    s_mul_i32 s48, s51, 28672
    s_add_u32 s53, s53, s48
    s_lshl_b32 s52, s52, 13
    s_lshl_b32 s51, s51, 12
    s_add_u32 m0, s52, s51
    s_nop 0
    buffer_load_dwordx4 v4, s[32:35], s53 offen offset:0 lds
    buffer_load_dwordx4 v5, s[32:35], s53 offen offset:1024 lds
    buffer_load_dwordx4 v6, s[32:35], s53 offen offset:2048 lds
    buffer_load_dwordx4 v7, s[32:35], s53 offen offset:3072 lds
    s_add_u32 s52, s61, 24
    s_and_b32 s51, s52, 1
    s_lshr_b32 s52, s52, 1
    s_cmp_ge_u32 s52, 7
    s_cselect_b32 s32, s86, s84
    s_cselect_b32 s33, s87, s85
    s_cselect_b32 s53, 7, 0
    s_mov_b32 s34, 0x62000
    s_mov_b32 s35, 0x20000
    s_sub_u32 s53, s52, s53
    s_lshl_b32 s53, s53, 7
    s_mul_i32 s48, s5, 57344
    s_add_u32 s53, s53, s48
    s_mul_i32 s48, s51, 28672
    s_add_u32 s53, s53, s48
    s_lshl_b32 s52, s52, 13
    s_lshl_b32 s51, s51, 12
    s_add_u32 m0, s52, s51
    s_nop 0
    buffer_load_dwordx4 v4, s[32:35], s53 offen offset:0 lds
    buffer_load_dwordx4 v5, s[32:35], s53 offen offset:1024 lds
    buffer_load_dwordx4 v6, s[32:35], s53 offen offset:2048 lds
    buffer_load_dwordx4 v7, s[32:35], s53 offen offset:3072 lds
    v_mul_f32 v97, v221, v221
    v_fma_f32 v96, v220, v220, -v97
    v_mul_f32 v97, v220, v221
    v_add_f32 v97, v97, v97
    v_mul_f32 v99, v97, v97
    v_fma_f32 v98, v96, v96, -v99
    v_mul_f32 v99, v96, v97
    v_add_f32 v99, v99, v99
    v_mov_b32 v100, 1.0
    v_mov_b32 v101, 0
    s_cmp_eq_u32 s56, 0
    s_cbranch_scc1 L_pw_47
    v_mov_b32 v100, v218
    v_mov_b32 v101, v219
    s_cmp_eq_u32 s56, 1
    s_cbranch_scc1 L_pw_47
    v_mov_b32 v100, v220
    v_mov_b32 v101, v221
    s_cmp_eq_u32 s56, 2
    s_cbranch_scc1 L_pw_47
    v_mul_f32 v100, v220, v218
    v_fma_f32 v100, -v221, v219, v100
    v_mul_f32 v101, v220, v219
    v_fma_f32 v101, v221, v218, v101
L_pw_47:
    s_cmp_eq_u32 s62, 0
    s_cbranch_scc0 L_rt1h_49
    s_cmp_eq_u32 s57, 0
    s_cbranch_scc1 L_noH_48
    s_add_u32 s56, s57, 1
    s_lshr_b32 s56, s56, 1
    v_mov_b32 v13, 7168
    v_cndmask_b32 v13, v13, v247, s[46:47]
    v_add_u32 v82, v82, v13
    s_sub_u32 s55, s57, 1
    s_mul_i32 s55, s55, 7168
    s_add_u32 s55, s55, s54
    s_add_u32 s55, s55, 589824
    v_mov_b32 v12, 159772
    s_mov_b32 s48, 0x400000
L_lw_51:
    ds_read_b32 v13, v12
    s_waitcnt lgkmcnt(0)
    v_readfirstlane_b32 s49, v13
    s_sub_u32 s48, s48, 1
    s_cbranch_scc1 L_lwd_52
    s_cmp_ge_u32 s49, 256
    s_cbranch_scc1 L_lwd_52
    s_sleep 4
    s_branch L_lw_51
L_lwd_52:
    s_mov_b32 s58, 0x40000
L_pe_53:
    s_mov_b32 s48, s55
    buffer_load_dwordx4 v[128:131], v82, s[24:27], s48 offen sc1
    s_sub_u32 s48, s48, 14336
    s_cmp_le_u32 s56, 1
    s_cbranch_scc1 L_pel_54
    buffer_load_dwordx4 v[132:135], v82, s[24:27], s48 offen sc1
    s_sub_u32 s48, s48, 14336
    s_cmp_le_u32 s56, 2
    s_cbranch_scc1 L_pel_54
    buffer_load_dwordx4 v[136:139], v82, s[24:27], s48 offen sc1
    s_sub_u32 s48, s48, 14336
    s_cmp_le_u32 s56, 3
    s_cbranch_scc1 L_pel_54
    buffer_load_dwordx4 v[140:143], v82, s[24:27], s48 offen sc1
    s_sub_u32 s48, s48, 14336
L_pel_54:
    s_waitcnt vmcnt(0)
    v_xor_b32 v83, s6, v130
    s_cmp_le_u32 s56, 1
    s_cbranch_scc1 L_pec_55
    v_xor_b32 v84, s6, v134
    v_or_b32 v83, v83, v84
    s_cmp_le_u32 s56, 2
    s_cbranch_scc1 L_pec_55
    v_xor_b32 v84, s6, v138
    v_or_b32 v83, v83, v84
    s_cmp_le_u32 s56, 3
    s_cbranch_scc1 L_pec_55
    v_xor_b32 v84, s6, v142
    v_or_b32 v83, v83, v84
L_pec_55:
    v_cmp_ne_u32 vcc, 0, v83
    s_sub_u32 s58, s58, 1
    s_cbranch_scc1 L_peo_56
    s_nop 2
    s_cbranch_vccz L_peo_56
    s_sleep 16
    s_branch L_pe_53
L_peo_56:
    v_mov_b32 v102, 0
    v_mov_b32 v103, 0
    s_cmp_le_u32 s56, 3
    s_cbranch_scc1 L_hs_57
    v_fma_f32 v84, v98, v102, v140
    v_fma_f32 v85, v98, v103, v141
    v_fma_f32 v84, -v99, v103, v84
    v_fma_f32 v103, v99, v102, v85
    v_mov_b32 v102, v84
L_hs_57:
    s_cmp_le_u32 s56, 2
    s_cbranch_scc1 L_hs_58
    v_fma_f32 v84, v98, v102, v136
    v_fma_f32 v85, v98, v103, v137
    v_fma_f32 v84, -v99, v103, v84
    v_fma_f32 v103, v99, v102, v85
    v_mov_b32 v102, v84
L_hs_58:
    s_cmp_le_u32 s56, 1
    s_cbranch_scc1 L_hs_59
    v_fma_f32 v84, v98, v102, v132
    v_fma_f32 v85, v98, v103, v133
    v_fma_f32 v84, -v99, v103, v84
    v_fma_f32 v103, v99, v102, v85
    v_mov_b32 v102, v84
L_hs_59:
    v_fma_f32 v84, v98, v102, v128
    v_fma_f32 v85, v98, v103, v129
    v_fma_f32 v84, -v99, v103, v84
    v_fma_f32 v103, v99, v102, v85
    v_mov_b32 v102, v84
    v_mul_f32 v84, v96, v102
    v_fma_f32 v84, -v97, v103, v84
    v_mul_f32 v85, v96, v103
    v_fma_f32 v85, v97, v102, v85
    v_cndmask_b32 v102, v102, v84, s[46:47]
    v_cndmask_b32 v103, v103, v85, s[46:47]
    v_mov_b32 v84, v102
    v_mov_b32 v85, v103
    s_nop 1
    v_permlane32_swap_b32 v102, v84
    v_permlane32_swap_b32 v103, v85
    s_nop 1
    v_add_f32 v102, v102, v84
    v_add_f32 v103, v103, v85
    v_fma_f32 v84, v102, v100, v80
    v_fma_f32 v85, v103, v100, v81
    v_fma_f32 v84, -v103, v101, v84
    v_fma_f32 v85, v102, v101, v85
    v_mov_b32 v80, v84
    v_mov_b32 v81, v85
L_noH_48:
    s_lshl_b32 s48, s63, 8
    s_add_u32 s48, s48, 158720
    v_and_b32 v12, 31, v1
    v_lshlrev_b32 v12, 3, v12
    v_add_u32 v12, s48, v12
    ds_write_b64 v12, v[80:81]
    s_waitcnt lgkmcnt(0)
    v_mov_b32 v12, 159816
    v_mov_b32 v13, 1
    s_mov_b64 exec, 1
    ds_add_u32 v12, v13
    s_mov_b64 exec, -1
    s_branch L_hdone_50
L_rt1h_49:
    v_mov_b32 v12, 159816
    s_mov_b32 s48, 0x400000
L_lw_61:
    ds_read_b32 v13, v12
    s_waitcnt lgkmcnt(0)
    v_readfirstlane_b32 s49, v13
    s_sub_u32 s48, s48, 1
    s_cbranch_scc1 L_lwd_62
    s_cmp_ge_u32 s49, 2
    s_cbranch_scc1 L_lwd_62
    s_sleep 4
    s_branch L_lw_61
L_lwd_62:
    s_lshl_b32 s48, s63, 8
    s_add_u32 s48, s48, 158720
    v_and_b32 v12, 31, v1
    v_lshlrev_b32 v12, 3, v12
    v_add_u32 v12, s48, v12
    ds_read_b64 v[80:81], v12
    s_waitcnt lgkmcnt(0)
L_hdone_50:
    v_fma_f32 v12, v80, v78, v76
    v_fma_f32 v13, v81, v78, v77
    v_fma_f32 v12, -v81, v79, v12
    v_fma_f32 v13, v80, v79, v13
    v_fma_f32 v10, v212, v12, v32
    v_fma_f32 v11, v212, v13, v48
    v_fma_f32 v10, -v213, v13, v10
    v_fma_f32 v11, v213, v12, v11
    v_cvt_pk_bf16_f32 v32, v10, -v11
    ds_write_b16 v86, v32 offset:0
    ds_write_b16_d16_hi v86, v32 offset:64
    v_fma_f32 v12, v212, v10, v33
    v_fma_f32 v13, v212, v11, v49
    v_fma_f32 v12, -v213, v11, v12
    v_fma_f32 v13, v213, v10, v13
    v_cvt_pk_bf16_f32 v33, v12, -v13
    ds_write_b16 v86, v33 offset:128
    ds_write_b16_d16_hi v86, v33 offset:192
    v_fma_f32 v10, v212, v12, v34
    v_fma_f32 v11, v212, v13, v50
    v_fma_f32 v10, -v213, v13, v10
    v_fma_f32 v11, v213, v12, v11
    v_cvt_pk_bf16_f32 v34, v10, -v11
    ds_write_b16 v87, v34 offset:256
    ds_write_b16_d16_hi v87, v34 offset:320
    v_fma_f32 v12, v212, v10, v35
    v_fma_f32 v13, v212, v11, v51
    v_fma_f32 v12, -v213, v11, v12
    v_fma_f32 v13, v213, v10, v13
    v_cvt_pk_bf16_f32 v35, v12, -v13
    ds_write_b16 v87, v35 offset:384
    ds_write_b16_d16_hi v87, v35 offset:448
    v_fma_f32 v10, v212, v12, v36
    v_fma_f32 v11, v212, v13, v52
    v_fma_f32 v10, -v213, v13, v10
    v_fma_f32 v11, v213, v12, v11
    v_cvt_pk_bf16_f32 v36, v10, -v11
    ds_write_b16 v88, v36 offset:512
    ds_write_b16_d16_hi v88, v36 offset:576
    v_fma_f32 v12, v212, v10, v37
    v_fma_f32 v13, v212, v11, v53
    v_fma_f32 v12, -v213, v11, v12
    v_fma_f32 v13, v213, v10, v13
    v_cvt_pk_bf16_f32 v37, v12, -v13
    ds_write_b16 v88, v37 offset:640
    ds_write_b16_d16_hi v88, v37 offset:704
    v_fma_f32 v10, v212, v12, v38
    v_fma_f32 v11, v212, v13, v54
    v_fma_f32 v10, -v213, v13, v10
    v_fma_f32 v11, v213, v12, v11
    v_cvt_pk_bf16_f32 v38, v10, -v11
    ds_write_b16 v89, v38 offset:768
    ds_write_b16_d16_hi v89, v38 offset:832
    v_fma_f32 v12, v212, v10, v39
    v_fma_f32 v13, v212, v11, v55
    v_fma_f32 v12, -v213, v11, v12
    v_fma_f32 v13, v213, v10, v13
    v_cvt_pk_bf16_f32 v39, v12, -v13
    ds_write_b16 v89, v39 offset:896
    ds_write_b16_d16_hi v89, v39 offset:960
    v_fma_f32 v10, v212, v12, v40
    v_fma_f32 v11, v212, v13, v56
    v_fma_f32 v10, -v213, v13, v10
    v_fma_f32 v11, v213, v12, v11
    v_cvt_pk_bf16_f32 v40, v10, -v11
    ds_write_b16 v86, v40 offset:1088
    ds_write_b16_d16_hi v86, v40 offset:1024
    v_fma_f32 v12, v212, v10, v41
    v_fma_f32 v13, v212, v11, v57
    v_fma_f32 v12, -v213, v11, v12
    v_fma_f32 v13, v213, v10, v13
    v_cvt_pk_bf16_f32 v41, v12, -v13
    ds_write_b16 v86, v41 offset:1216
    ds_write_b16_d16_hi v86, v41 offset:1152
    v_fma_f32 v10, v212, v12, v42
    v_fma_f32 v11, v212, v13, v58
    v_fma_f32 v10, -v213, v13, v10
    v_fma_f32 v11, v213, v12, v11
    v_cvt_pk_bf16_f32 v42, v10, -v11
    ds_write_b16 v87, v42 offset:1344
    ds_write_b16_d16_hi v87, v42 offset:1280
    v_fma_f32 v12, v212, v10, v43
    v_fma_f32 v13, v212, v11, v59
    v_fma_f32 v12, -v213, v11, v12
    v_fma_f32 v13, v213, v10, v13
    v_cvt_pk_bf16_f32 v43, v12, -v13
    ds_write_b16 v87, v43 offset:1472
    ds_write_b16_d16_hi v87, v43 offset:1408
    v_fma_f32 v10, v212, v12, v44
    v_fma_f32 v11, v212, v13, v60
    v_fma_f32 v10, -v213, v13, v10
    v_fma_f32 v11, v213, v12, v11
    v_cvt_pk_bf16_f32 v44, v10, -v11
    ds_write_b16 v88, v44 offset:1600
    ds_write_b16_d16_hi v88, v44 offset:1536
    v_fma_f32 v12, v212, v10, v45
    v_fma_f32 v13, v212, v11, v61
    v_fma_f32 v12, -v213, v11, v12
    v_fma_f32 v13, v213, v10, v13
    v_cvt_pk_bf16_f32 v45, v12, -v13
    ds_write_b16 v88, v45 offset:1728
    ds_write_b16_d16_hi v88, v45 offset:1664
    v_fma_f32 v10, v212, v12, v46
    v_fma_f32 v11, v212, v13, v62
    v_fma_f32 v10, -v213, v13, v10
    v_fma_f32 v11, v213, v12, v11
    v_cvt_pk_bf16_f32 v46, v10, -v11
    ds_write_b16 v89, v46 offset:1856
    ds_write_b16_d16_hi v89, v46 offset:1792
    v_fma_f32 v12, v212, v10, v47
    v_fma_f32 v13, v212, v11, v63
    v_fma_f32 v12, -v213, v11, v12
    v_fma_f32 v13, v213, v10, v13
    v_cvt_pk_bf16_f32 v47, v12, -v13
    ds_write_b16 v89, v47 offset:1984
    ds_write_b16_d16_hi v89, v47 offset:1920
    s_lshl_b32 s48, s4, 1
    s_add_u32 s48, s48, s62
    s_mul_i32 s48, s48, 56
    s_lshl_b32 s49, s5, 2
    s_add_u32 s48, s48, s49
    s_lshl_b32 s49, s63, 1
    s_add_u32 s48, s48, s49
    s_lshl_b32 s48, s48, 10
    s_add_u32 s48, s48, 1048576
    s_add_u32 s49, s48, 28672
    s_waitcnt lgkmcnt(0)
    ds_read_b128 v[64:67], v90
    ds_read_b128 v[68:71], v91
    ds_read_b128 v[72:75], v92
    ds_read_b128 v[76:79], v93
    s_waitcnt lgkmcnt(0)
    buffer_store_dwordx4 v[64:67], v2, s[24:27], s48 offen sc1
    buffer_store_dwordx4 v[68:71], v2, s[24:27], s48 offen offset:1024 sc1
    buffer_store_dwordx4 v[72:75], v2, s[24:27], s49 offen sc1
    buffer_store_dwordx4 v[76:79], v2, s[24:27], s49 offen offset:1024 sc1
    v_mov_b32 v12, 159764
    v_mov_b32 v13, 1
    s_mov_b64 exec, 1
    ds_add_u32 v12, v13
    s_mov_b64 exec, -1
    s_waitcnt vmcnt(0)
    s_lshl_b32 s52, s5, 2
    s_add_u32 s52, s52, s61
    s_lshl_b32 s50, s4, 7
    s_lshl_b32 s51, s52, 2
    s_add_u32 s50, s50, s51
    s_add_u32 s50, s50, 524288
    v_mov_b32 v12, s50
    v_mov_b32 v13, s6
    s_mov_b64 exec, 1
    buffer_store_dword v13, v12, s[24:27], 0 offen sc1
    s_mov_b64 exec, -1
    s_lshl_b32 s48, s4, 1
    s_add_u32 s48, s48, s62
    s_mul_i32 s48, s48, 56
    s_lshl_b32 s49, s5, 2
    s_add_u32 s48, s48, s49
    s_lshl_b32 s49, s63, 1
    s_add_u32 s48, s48, s49
    s_lshl_b32 s48, s48, 10
    s_add_u32 s48, s48, 1048576
    v_and_b32 v12, 15, v1
    v_lshlrev_b32 v12, 7, v12
    v_bfe_u32 v13, v1, 4, 1
    v_mul_u32_u24 v13, 28672, v13
    v_add_u32 v12, v12, v13
    v_mov_b32 v12, 159772
    s_mov_b32 s48, 0x400000
L_lw_63:
    ds_read_b32 v13, v12
    s_waitcnt lgkmcnt(0)
    v_readfirstlane_b32 s49, v13
    s_sub_u32 s48, s48, 1
    s_cbranch_scc1 L_lwd_64
    s_cmp_ge_u32 s49, 512
    s_cbranch_scc1 L_lwd_64
    s_sleep 8
    s_branch L_lw_63
L_lwd_64:
    s_mul_i32 s48, s63, 61440
    v_and_b32 v13, 31, v1
    v_lshrrev_b32 v14, 5, v1
    v_lshrrev_b32 v15, 1, v13
    v_and_b32 v15, 7, v15
    v_lshlrev_b32 v12, 7, v13
    v_add_u32 v12, s48, v12
    v_xor_b32 v15, v15, v14
    v_xor_b32 v11, 0, v15
    v_lshl_add_u32 v248, v11, 4, v12
    v_xor_b32 v11, 2, v15
    v_lshl_add_u32 v249, v11, 4, v12
    v_xor_b32 v11, 4, v15
    v_lshl_add_u32 v250, v11, 4, v12
    v_xor_b32 v11, 6, v15
    v_lshl_add_u32 v251, v11, 4, v12
    v_xor_b32 v252, 0x1000, v248
    v_xor_b32 v253, 0x1000, v249
    v_xor_b32 v254, 0x1000, v250
    v_xor_b32 v255, 0x1000, v251
    v_lshlrev_b32 v208, 16, v224
    v_lshlrev_b32 v209, 16, v225
    v_lshlrev_b32 v210, 16, v226
    v_lshlrev_b32 v211, 16, v227
    v_lshlrev_b32 v212, 16, v228
    v_lshlrev_b32 v213, 16, v229
    v_lshlrev_b32 v214, 16, v230
    v_lshlrev_b32 v215, 16, v231
    v_lshlrev_b32 v216, 16, v232
    v_lshlrev_b32 v217, 16, v233
    v_lshlrev_b32 v218, 16, v234
    v_lshlrev_b32 v219, 16, v235
    v_lshlrev_b32 v220, 16, v236
    v_lshlrev_b32 v221, 16, v237
    v_lshlrev_b32 v222, 16, v238
    v_lshlrev_b32 v223, 16, v239
    v_mul_f32 v208, v9, v208
    v_mul_f32 v209, v9, v209
    v_mul_f32 v210, v9, v210
    v_mul_f32 v211, v9, v211
    v_mul_f32 v212, v9, v212
    v_mul_f32 v213, v9, v213
    v_mul_f32 v214, v9, v214
    v_mul_f32 v215, v9, v215
    v_mul_f32 v216, v9, v216
    v_mul_f32 v217, v9, v217
    v_mul_f32 v218, v9, v218
    v_mul_f32 v219, v9, v219
    v_mul_f32 v220, v9, v220
    v_mul_f32 v221, v9, v221
    v_mul_f32 v222, v9, v222
    v_mul_f32 v223, v9, v223
    v_sub_f32 v192, 1.0, v192
    v_sub_f32 v193, 1.0, v193
    v_sub_f32 v194, 1.0, v194
    v_sub_f32 v195, 1.0, v195
    v_sub_f32 v196, 1.0, v196
    v_sub_f32 v197, 1.0, v197
    v_sub_f32 v198, 1.0, v198
    v_sub_f32 v199, 1.0, v199
    v_sub_f32 v200, 1.0, v200
    v_sub_f32 v201, 1.0, v201
    v_sub_f32 v202, 1.0, v202
    v_sub_f32 v203, 1.0, v203
    v_sub_f32 v204, 1.0, v204
    v_sub_f32 v205, 1.0, v205
    v_sub_f32 v206, 1.0, v206
    v_sub_f32 v207, 1.0, v207
    v_add_f32 v192, v192, v192
    v_add_f32 v193, v193, v193
    v_add_f32 v194, v194, v194
    v_add_f32 v195, v195, v195
    v_add_f32 v196, v196, v196
    v_add_f32 v197, v197, v197
    v_add_f32 v198, v198, v198
    v_add_f32 v199, v199, v199
    v_add_f32 v200, v200, v200
    v_add_f32 v201, v201, v201
    v_add_f32 v202, v202, v202
    v_add_f32 v203, v203, v203
    v_add_f32 v204, v204, v204
    v_add_f32 v205, v205, v205
    v_add_f32 v206, v206, v206
    v_add_f32 v207, v207, v207
    v_mov_b32 v12, 159772
    s_mov_b32 s48, 0x400000
L_lw_65:
    ds_read_b32 v13, v12
    s_waitcnt lgkmcnt(0)
    v_readfirstlane_b32 s49, v13
    s_sub_u32 s48, s48, 1
    s_cbranch_scc1 L_lwd_66
    s_cmp_ge_u32 s49, 768
    s_cbranch_scc1 L_lwd_66
    s_sleep 4
    s_branch L_lw_65
L_lwd_66:
    s_waitcnt vmcnt(0)
    s_cmp_eq_u32 s3, 4
    s_cbranch_scc0 L_wfo_69
    v_lshlrev_b32 v12, 2, v1
    s_mov_b32 s48, 0x100000
    s_mov_b32 s50, 573440
    s_lshl_b32 s51, s4, 7
    s_add_u32 s51, s51, 524288
    v_min_u32 v15, 27, v1
    v_lshlrev_b32 v15, 2, v15
L_wf_67:
    buffer_load_dword v13, v12, s[24:27], s50 offen sc1
    buffer_load_dword v14, v12, s[24:27], s50 offen offset:256 sc1
    buffer_load_dword v10, v15, s[24:27], s51 offen sc1
    s_waitcnt vmcnt(0)
    v_xor_b32 v13, s6, v13
    v_xor_b32 v14, s6, v14
    v_xor_b32 v10, s6, v10
    v_or3_b32 v13, v13, v14, v10
    v_cmp_ne_u32 vcc, 0, v13
    s_sub_u32 s48, s48, 1
    s_cbranch_scc1 L_wfd_68
    s_nop 2
    s_cbranch_vccz L_wfd_68
    s_sleep 12
    s_branch L_wf_67
L_wfd_68:
    v_mov_b32 v12, 159812
    v_mov_b32 v13, 1
    s_mov_b64 exec, 1
    ds_add_u32 v12, v13
    s_mov_b64 exec, -1
    s_branch L_wfe_70
L_wfo_69:
    v_mov_b32 v12, 159812
    s_mov_b32 s48, 0x400000
L_lw_71:
    ds_read_b32 v13, v12
    s_waitcnt lgkmcnt(0)
    v_readfirstlane_b32 s49, v13
    s_sub_u32 s48, s48, 1
    s_cbranch_scc1 L_lwd_72
    s_cmp_ge_u32 s49, 1
    s_cbranch_scc1 L_lwd_72
    s_sleep 2
    s_branch L_lw_71
L_lwd_72:
L_wfe_70:
    v_mov_b32 v12, 159804
    v_mov_b32 v13, 1
    s_mov_b64 exec, 1
    ds_add_u32 v12, v13
    s_mov_b64 exec, -1
    s_lshl_b32 s53, s5, 5
    s_lshl_b32 s48, s63, 4
    s_add_u32 s53, s53, s48
    s_lshl_b32 s53, s53, 11
    s_add_u32 s53, s53, 6815744
    s_lshl_b32 s48, s63, 10
    v_add_u32 v4, s48, v2
    v_xor_b32 v5, 0x400, v4
    s_lshl_b32 s54, s4, 1
    s_add_u32 s54, s54, s62
    s_mul_i32 s50, s54, 57344
    s_mul_i32 s49, s63, 28672
    s_add_u32 s50, s50, s49
    s_add_u32 s50, s50, 1048576
    s_lshl_b32 s54, s54, 4
    s_lshl_b32 s49, s63, 3
    s_add_u32 s54, s54, s49
    s_lshl_b32 s54, s54, 11
    s_add_u32 s54, s54, 4718592
    s_mov_b32 s56, s50
    v_mov_b32 v12, 159772
    s_mov_b32 s48, 0x400000
L_lw_73:
    ds_read_b32 v13, v12
    s_waitcnt lgkmcnt(0)
    v_readfirstlane_b32 s49, v13
    s_sub_u32 s48, s48, 1
    s_cbranch_scc1 L_lwd_74
    s_cmp_ge_u32 s49, 1024
    s_cbranch_scc1 L_lwd_74
    s_sleep 1
    s_branch L_lw_73
L_lwd_74:
    s_mov_b32 s50, s56
    buffer_load_dwordx4 v[16:19], v2, s[24:27], s50 offen offset:0 sc1
    buffer_load_dwordx4 v[20:23], v2, s[24:27], s50 offen offset:1024 sc1
    buffer_load_dwordx4 v[24:27], v2, s[24:27], s50 offen offset:2048 sc1
    buffer_load_dwordx4 v[28:31], v2, s[24:27], s50 offen offset:3072 sc1
    s_add_u32 s50, s50, 4096
    buffer_load_dwordx4 v[32:35], v2, s[24:27], s50 offen offset:0 sc1
    buffer_load_dwordx4 v[36:39], v2, s[24:27], s50 offen offset:1024 sc1
    buffer_load_dwordx4 v[40:43], v2, s[24:27], s50 offen offset:2048 sc1
    buffer_load_dwordx4 v[44:47], v2, s[24:27], s50 offen offset:3072 sc1
    s_add_u32 s50, s50, 4096
    buffer_load_dwordx4 v[48:51], v2, s[24:27], s50 offen offset:0 sc1
    buffer_load_dwordx4 v[52:55], v2, s[24:27], s50 offen offset:1024 sc1
    buffer_load_dwordx4 v[56:59], v2, s[24:27], s50 offen offset:2048 sc1
    buffer_load_dwordx4 v[60:63], v2, s[24:27], s50 offen offset:3072 sc1
    s_add_u32 s50, s50, 4096
    buffer_load_dwordx4 v[64:67], v2, s[24:27], s50 offen offset:0 sc1
    buffer_load_dwordx4 v[68:71], v2, s[24:27], s50 offen offset:1024 sc1
    buffer_load_dwordx4 v[72:75], v2, s[24:27], s50 offen offset:2048 sc1
    buffer_load_dwordx4 v[76:79], v2, s[24:27], s50 offen offset:3072 sc1
    s_add_u32 s50, s50, 4096
    buffer_load_dwordx4 v[80:83], v2, s[24:27], s50 offen offset:0 sc1
    buffer_load_dwordx4 v[84:87], v2, s[24:27], s50 offen offset:1024 sc1
    buffer_load_dwordx4 v[88:91], v2, s[24:27], s50 offen offset:2048 sc1
    buffer_load_dwordx4 v[92:95], v2, s[24:27], s50 offen offset:3072 sc1
    s_add_u32 s50, s50, 4096
    buffer_load_dwordx4 v[96:99], v2, s[24:27], s50 offen offset:0 sc1
    buffer_load_dwordx4 v[100:103], v2, s[24:27], s50 offen offset:1024 sc1
    buffer_load_dwordx4 v[104:107], v2, s[24:27], s50 offen offset:2048 sc1
    buffer_load_dwordx4 v[108:111], v2, s[24:27], s50 offen offset:3072 sc1
    s_add_u32 s50, s50, 4096
    buffer_load_dwordx4 v[112:115], v2, s[24:27], s50 offen offset:0 sc1
    buffer_load_dwordx4 v[116:119], v2, s[24:27], s50 offen offset:1024 sc1
    buffer_load_dwordx4 v[120:123], v2, s[24:27], s50 offen offset:2048 sc1
    buffer_load_dwordx4 v[124:127], v2, s[24:27], s50 offen offset:3072 sc1
    s_add_u32 s50, s50, 4096
    s_mov_b32 s32, s94
    s_mov_b32 s33, s95
    s_mov_b32 s34, 0x380000
    s_mov_b32 s35, 0x20000
    v_lshrrev_b32 v12, 5, v1
    v_mul_u32_u24 v12, 28672, v12
    v_and_b32 v13, 31, v1
    v_lshl_add_u32 v11, v13, 2, v12
    s_lshl_b32 s52, s4, 6
    s_lshl_b32 s49, s62, 5
    s_add_u32 s52, s52, s49
    s_mul_i32 s52, s52, 1792
    s_lshl_b32 s49, s5, 8
    s_add_u32 s52, s52, s49
    s_lshl_b32 s49, s63, 7
    s_add_u32 s52, s52, s49
    v_mov_b32 v12, 159804
    s_mov_b32 s48, 0x400000
L_lw_75:
    ds_read_b32 v13, v12
    s_waitcnt lgkmcnt(0)
    v_readfirstlane_b32 s49, v13
    s_sub_u32 s48, s48, 1
    s_cbranch_scc1 L_lwd_76
    s_cmp_ge_u32 s49, 4
    s_cbranch_scc1 L_lwd_76
    s_branch L_lw_75
L_lwd_76:
    v_mov_b32 v12, 159768
    s_mov_b32 s48, 0x400000
L_lw_77:
    ds_read_b32 v13, v12
    s_waitcnt lgkmcnt(0)
    v_readfirstlane_b32 s49, v13
    s_sub_u32 s48, s48, 1
    s_cbranch_scc1 L_lwd_78
    s_cmp_ge_u32 s49, 4
    s_cbranch_scc1 L_lwd_78
    s_sleep 1
    s_branch L_lw_77
L_lwd_78:
    s_setprio 0
    ds_read_b128 v[224:227], v248 offset:0
    ds_read_b128 v[228:231], v252 offset:0
    ds_read_b128 v[232:235], v249 offset:0
    ds_read_b128 v[236:239], v253 offset:0
    ds_read_b128 v[240:243], v250 offset:0
    ds_read_b128 v[244:247], v254 offset:0
    ds_read_b128 v[160:163], v251 offset:0
    ds_read_b128 v[164:167], v255 offset:0
    ds_read_b128 v[168:171], v248 offset:8192
    ds_read_b128 v[172:175], v252 offset:8192
    ds_read_b128 v[176:179], v249 offset:8192
    ds_read_b128 v[180:183], v253 offset:8192
    s_waitcnt vmcnt(27) lgkmcnt(10)
    v_mfma_f32_32x32x16_bf16 v[128:143], v[16:19], v[224:227], v[208:223]
    ds_read_b128 v[184:187], v250 offset:8192
    v_mfma_f32_32x32x16_bf16 v[144:159], v[16:19], v[228:231], 0
    ds_read_b128 v[188:191], v254 offset:8192
    s_waitcnt vmcnt(26) lgkmcnt(10)
    v_mfma_f32_32x32x16_bf16 v[128:143], v[20:23], v[232:235], v[128:143]
    ds_read_b128 v[224:227], v251 offset:8192
    ds_read_b128 v[228:231], v255 offset:8192
    v_mfma_f32_32x32x16_bf16 v[144:159], v[20:23], v[236:239], v[144:159]
    buffer_load_dwordx4 v[16:19], v4, s[24:27], s53 offen offset:0 sc1
    s_waitcnt vmcnt(26) lgkmcnt(10)
    v_mfma_f32_32x32x16_bf16 v[128:143], v[24:27], v[240:243], v[128:143]
    ds_read_b128 v[232:235], v248 offset:16384
    ds_read_b128 v[236:239], v252 offset:16384
    v_mfma_f32_32x32x16_bf16 v[144:159], v[24:27], v[244:247], v[144:159]
    buffer_load_dwordx4 v[20:23], v5, s[24:27], s53 offen offset:0 sc1
    s_waitcnt vmcnt(26) lgkmcnt(10)
    v_mfma_f32_32x32x16_bf16 v[128:143], v[28:31], v[160:163], v[128:143]
    ds_read_b128 v[240:243], v249 offset:16384
    ds_read_b128 v[244:247], v253 offset:16384
    v_mfma_f32_32x32x16_bf16 v[144:159], v[28:31], v[164:167], v[144:159]
    buffer_load_dwordx4 v[24:27], v4, s[24:27], s53 offen offset:2048 sc1
    s_waitcnt vmcnt(26) lgkmcnt(10)
    v_mfma_f32_32x32x16_bf16 v[128:143], v[32:35], v[168:171], v[128:143]
    ds_read_b128 v[160:163], v250 offset:16384
    ds_read_b128 v[164:167], v254 offset:16384
    v_mfma_f32_32x32x16_bf16 v[144:159], v[32:35], v[172:175], v[144:159]
    buffer_load_dwordx4 v[28:31], v5, s[24:27], s53 offen offset:2048 sc1
    s_add_u32 s53, s53, 4096
    s_waitcnt vmcnt(26) lgkmcnt(10)
    v_mfma_f32_32x32x16_bf16 v[128:143], v[36:39], v[176:179], v[128:143]
    ds_read_b128 v[168:171], v251 offset:16384
    ds_read_b128 v[172:175], v255 offset:16384
    v_mfma_f32_32x32x16_bf16 v[144:159], v[36:39], v[180:183], v[144:159]
    buffer_load_dwordx4 v[32:35], v4, s[24:27], s53 offen offset:0 sc1
    s_waitcnt vmcnt(26) lgkmcnt(10)
    v_mfma_f32_32x32x16_bf16 v[128:143], v[40:43], v[184:187], v[128:143]
    ds_read_b128 v[176:179], v248 offset:24576
    ds_read_b128 v[180:183], v252 offset:24576
    v_mfma_f32_32x32x16_bf16 v[144:159], v[40:43], v[188:191], v[144:159]
    buffer_load_dwordx4 v[36:39], v5, s[24:27], s53 offen offset:0 sc1
    s_waitcnt vmcnt(26) lgkmcnt(10)
    v_mfma_f32_32x32x16_bf16 v[128:143], v[44:47], v[224:227], v[128:143]
    ds_read_b128 v[184:187], v249 offset:24576
    ds_read_b128 v[188:191], v253 offset:24576
    v_mfma_f32_32x32x16_bf16 v[144:159], v[44:47], v[228:231], v[144:159]
    buffer_load_dwordx4 v[40:43], v4, s[24:27], s53 offen offset:2048 sc1
    s_waitcnt vmcnt(26) lgkmcnt(10)
    v_mfma_f32_32x32x16_bf16 v[128:143], v[48:51], v[232:235], v[128:143]
    ds_read_b128 v[224:227], v250 offset:24576
    ds_read_b128 v[228:231], v254 offset:24576
    v_mfma_f32_32x32x16_bf16 v[144:159], v[48:51], v[236:239], v[144:159]
    buffer_load_dwordx4 v[44:47], v5, s[24:27], s53 offen offset:2048 sc1
    s_add_u32 s53, s53, 4096
    s_waitcnt vmcnt(26) lgkmcnt(10)
    v_mfma_f32_32x32x16_bf16 v[128:143], v[52:55], v[240:243], v[128:143]
    ds_read_b128 v[232:235], v251 offset:24576
    ds_read_b128 v[236:239], v255 offset:24576
    v_mfma_f32_32x32x16_bf16 v[144:159], v[52:55], v[244:247], v[144:159]
    buffer_load_dwordx4 v[48:51], v4, s[24:27], s53 offen offset:0 sc1
    s_waitcnt vmcnt(26) lgkmcnt(10)
    v_mfma_f32_32x32x16_bf16 v[128:143], v[56:59], v[160:163], v[128:143]
    ds_read_b128 v[240:243], v248 offset:32768
    ds_read_b128 v[244:247], v252 offset:32768
    v_mfma_f32_32x32x16_bf16 v[144:159], v[56:59], v[164:167], v[144:159]
    buffer_load_dwordx4 v[52:55], v5, s[24:27], s53 offen offset:0 sc1
    s_waitcnt vmcnt(26) lgkmcnt(10)
    v_mfma_f32_32x32x16_bf16 v[128:143], v[60:63], v[168:171], v[128:143]
    ds_read_b128 v[160:163], v249 offset:32768
    ds_read_b128 v[164:167], v253 offset:32768
    v_mfma_f32_32x32x16_bf16 v[144:159], v[60:63], v[172:175], v[144:159]
    buffer_load_dwordx4 v[56:59], v4, s[24:27], s53 offen offset:2048 sc1
    s_waitcnt vmcnt(26) lgkmcnt(10)
    v_mfma_f32_32x32x16_bf16 v[128:143], v[64:67], v[176:179], v[128:143]
    ds_read_b128 v[168:171], v250 offset:32768
    ds_read_b128 v[172:175], v254 offset:32768
    v_mfma_f32_32x32x16_bf16 v[144:159], v[64:67], v[180:183], v[144:159]
    buffer_load_dwordx4 v[60:63], v5, s[24:27], s53 offen offset:2048 sc1
    s_add_u32 s53, s53, 4096
    s_waitcnt vmcnt(26) lgkmcnt(10)
    v_mfma_f32_32x32x16_bf16 v[128:143], v[68:71], v[184:187], v[128:143]
    ds_read_b128 v[176:179], v251 offset:32768
    ds_read_b128 v[180:183], v255 offset:32768
    v_mfma_f32_32x32x16_bf16 v[144:159], v[68:71], v[188:191], v[144:159]
    buffer_load_dwordx4 v[64:67], v4, s[24:27], s53 offen offset:0 sc1
    s_waitcnt vmcnt(26) lgkmcnt(10)
    v_mfma_f32_32x32x16_bf16 v[128:143], v[72:75], v[224:227], v[128:143]
    ds_read_b128 v[184:187], v248 offset:40960
    ds_read_b128 v[188:191], v252 offset:40960
    v_mfma_f32_32x32x16_bf16 v[144:159], v[72:75], v[228:231], v[144:159]
    buffer_load_dwordx4 v[68:71], v5, s[24:27], s53 offen offset:0 sc1
    s_waitcnt vmcnt(26) lgkmcnt(10)
    v_mfma_f32_32x32x16_bf16 v[128:143], v[76:79], v[232:235], v[128:143]
    ds_read_b128 v[224:227], v249 offset:40960
    ds_read_b128 v[228:231], v253 offset:40960
    v_mfma_f32_32x32x16_bf16 v[144:159], v[76:79], v[236:239], v[144:159]
    buffer_load_dwordx4 v[72:75], v4, s[24:27], s53 offen offset:2048 sc1
    s_waitcnt vmcnt(26) lgkmcnt(10)
    v_mfma_f32_32x32x16_bf16 v[128:143], v[80:83], v[240:243], v[128:143]
    ds_read_b128 v[232:235], v250 offset:40960
    ds_read_b128 v[236:239], v254 offset:40960
    v_mfma_f32_32x32x16_bf16 v[144:159], v[80:83], v[244:247], v[144:159]
    buffer_load_dwordx4 v[76:79], v5, s[24:27], s53 offen offset:2048 sc1
    s_add_u32 s53, s53, 4096
    s_waitcnt vmcnt(26) lgkmcnt(10)
    v_mfma_f32_32x32x16_bf16 v[128:143], v[84:87], v[160:163], v[128:143]
    ds_read_b128 v[240:243], v251 offset:40960
    ds_read_b128 v[244:247], v255 offset:40960
    v_mfma_f32_32x32x16_bf16 v[144:159], v[84:87], v[164:167], v[144:159]
    buffer_load_dwordx4 v[80:83], v4, s[24:27], s53 offen offset:0 sc1
    s_waitcnt vmcnt(26) lgkmcnt(10)
    v_mfma_f32_32x32x16_bf16 v[128:143], v[88:91], v[168:171], v[128:143]
    ds_read_b128 v[160:163], v248 offset:49152
    ds_read_b128 v[164:167], v252 offset:49152
    v_mfma_f32_32x32x16_bf16 v[144:159], v[88:91], v[172:175], v[144:159]
    buffer_load_dwordx4 v[84:87], v5, s[24:27], s53 offen offset:0 sc1
    s_waitcnt vmcnt(26) lgkmcnt(10)
    v_mfma_f32_32x32x16_bf16 v[128:143], v[92:95], v[176:179], v[128:143]
    ds_read_b128 v[168:171], v249 offset:49152
    ds_read_b128 v[172:175], v253 offset:49152
    v_mfma_f32_32x32x16_bf16 v[144:159], v[92:95], v[180:183], v[144:159]
    buffer_load_dwordx4 v[88:91], v4, s[24:27], s53 offen offset:2048 sc1
    s_waitcnt vmcnt(26) lgkmcnt(10)
    v_mfma_f32_32x32x16_bf16 v[128:143], v[96:99], v[184:187], v[128:143]
    ds_read_b128 v[176:179], v250 offset:49152
    ds_read_b128 v[180:183], v254 offset:49152
    v_mfma_f32_32x32x16_bf16 v[144:159], v[96:99], v[188:191], v[144:159]
    buffer_load_dwordx4 v[92:95], v5, s[24:27], s53 offen offset:2048 sc1
    s_add_u32 s53, s53, 4096
    s_waitcnt vmcnt(26) lgkmcnt(10)
    v_mfma_f32_32x32x16_bf16 v[128:143], v[100:103], v[224:227], v[128:143]
    ds_read_b128 v[184:187], v251 offset:49152
    ds_read_b128 v[188:191], v255 offset:49152
    v_mfma_f32_32x32x16_bf16 v[144:159], v[100:103], v[228:231], v[144:159]
    buffer_load_dwordx4 v[96:99], v4, s[24:27], s53 offen offset:0 sc1
    s_waitcnt vmcnt(26) lgkmcnt(10)
    v_mfma_f32_32x32x16_bf16 v[128:143], v[104:107], v[232:235], v[128:143]
    buffer_load_dwordx4 v[100:103], v5, s[24:27], s53 offen offset:0 sc1
    v_mfma_f32_32x32x16_bf16 v[144:159], v[104:107], v[236:239], v[144:159]
    s_waitcnt vmcnt(26) lgkmcnt(8)
    v_mfma_f32_32x32x16_bf16 v[128:143], v[108:111], v[240:243], v[128:143]
    buffer_load_dwordx4 v[104:107], v4, s[24:27], s53 offen offset:2048 sc1
    v_mfma_f32_32x32x16_bf16 v[144:159], v[108:111], v[244:247], v[144:159]
    s_waitcnt vmcnt(26) lgkmcnt(6)
    v_mfma_f32_32x32x16_bf16 v[128:143], v[112:115], v[160:163], v[128:143]
    buffer_load_dwordx4 v[108:111], v5, s[24:27], s53 offen offset:2048 sc1
    v_mfma_f32_32x32x16_bf16 v[144:159], v[112:115], v[164:167], v[144:159]
    s_add_u32 s53, s53, 4096
    s_waitcnt vmcnt(26) lgkmcnt(4)
    v_mfma_f32_32x32x16_bf16 v[128:143], v[116:119], v[168:171], v[128:143]
    buffer_load_dwordx4 v[112:115], v4, s[24:27], s53 offen offset:0 sc1
    v_mfma_f32_32x32x16_bf16 v[144:159], v[116:119], v[172:175], v[144:159]
    s_waitcnt vmcnt(26) lgkmcnt(2)
    v_mfma_f32_32x32x16_bf16 v[128:143], v[120:123], v[176:179], v[128:143]
    buffer_load_dwordx4 v[116:119], v5, s[24:27], s53 offen offset:0 sc1
    v_mfma_f32_32x32x16_bf16 v[144:159], v[120:123], v[180:183], v[144:159]
    s_waitcnt vmcnt(26) lgkmcnt(0)
    v_mfma_f32_32x32x16_bf16 v[128:143], v[124:127], v[184:187], v[128:143]
    buffer_load_dwordx4 v[120:123], v4, s[24:27], s53 offen offset:2048 sc1
    v_mfma_f32_32x32x16_bf16 v[144:159], v[124:127], v[188:191], v[144:159]
    buffer_load_dwordx4 v[124:127], v5, s[24:27], s53 offen offset:2048 sc1
    s_add_u32 s53, s53, 4096
    buffer_load_dwordx4 v[208:211], v4, s[24:27], s53 offen offset:0 sc1
    buffer_load_dwordx4 v[212:215], v5, s[24:27], s53 offen offset:0 sc1
    buffer_load_dwordx4 v[216:219], v4, s[24:27], s53 offen offset:2048 sc1
    buffer_load_dwordx4 v[220:223], v5, s[24:27], s53 offen offset:2048 sc1
    s_add_u32 s53, s53, 4096
    s_mov_b32 s56, s54
    s_add_u32 s57, s54, 4096
    s_add_u32 s58, s54, 8192
    s_add_u32 s59, s54, 12288
    s_mov_b32 s55, 0x40000
    buffer_load_dwordx4 v[160:163], v2, s[24:27], s56 offen offset:0 sc1
    buffer_load_dwordx4 v[164:167], v2, s[24:27], s56 offen offset:1024 sc1
    buffer_load_dwordx4 v[168:171], v2, s[24:27], s56 offen offset:2048 sc1
    buffer_load_dwordx4 v[172:175], v2, s[24:27], s56 offen offset:3072 sc1
    buffer_load_dwordx4 v[176:179], v2, s[24:27], s57 offen offset:0 sc1
    buffer_load_dwordx4 v[180:183], v2, s[24:27], s57 offen offset:1024 sc1
    buffer_load_dwordx4 v[184:187], v2, s[24:27], s57 offen offset:2048 sc1
    buffer_load_dwordx4 v[188:191], v2, s[24:27], s57 offen offset:3072 sc1
    buffer_load_dwordx4 v[224:227], v2, s[24:27], s59 offen offset:0 sc1
    buffer_load_dwordx4 v[228:231], v2, s[24:27], s59 offen offset:1024 sc1
    buffer_load_dwordx4 v[232:235], v2, s[24:27], s59 offen offset:2048 sc1
    buffer_load_dwordx4 v[236:239], v2, s[24:27], s59 offen offset:3072 sc1
    v_mul_f32 v128, v192, v128
    v_mul_f32 v144, v192, v144
    v_mul_f32 v129, v193, v129
    v_mul_f32 v145, v193, v145
    v_mul_f32 v130, v194, v130
    v_mul_f32 v146, v194, v146
    v_mul_f32 v131, v195, v131
    v_mul_f32 v147, v195, v147
    v_mul_f32 v132, v196, v132
    v_mul_f32 v148, v196, v148
    v_mul_f32 v133, v197, v133
    v_mul_f32 v149, v197, v149
    v_mul_f32 v134, v198, v134
    v_mul_f32 v150, v198, v150
    v_mul_f32 v135, v199, v135
    v_mul_f32 v151, v199, v151
    v_mul_f32 v136, v200, v136
    v_mul_f32 v152, v200, v152
    v_mul_f32 v137, v201, v137
    v_mul_f32 v153, v201, v153
    v_mul_f32 v138, v202, v138
    v_mul_f32 v154, v202, v154
    v_mul_f32 v139, v203, v139
    v_mul_f32 v155, v203, v155
    v_mul_f32 v140, v204, v140
    v_mul_f32 v156, v204, v156
    v_mul_f32 v141, v205, v141
    v_mul_f32 v157, v205, v157
    v_mul_f32 v142, v206, v142
    v_mul_f32 v158, v206, v158
    v_mul_f32 v143, v207, v143
    v_mul_f32 v159, v207, v159
    buffer_load_dwordx4 v[192:195], v2, s[24:27], s58 offen offset:0 sc1
    buffer_load_dwordx4 v[196:199], v2, s[24:27], s58 offen offset:1024 sc1
    buffer_load_dwordx4 v[200:203], v2, s[24:27], s58 offen offset:2048 sc1
    buffer_load_dwordx4 v[204:207], v2, s[24:27], s58 offen offset:3072 sc1
    s_branch L_of2_81
L_of_79:
    buffer_load_dwordx4 v[160:163], v2, s[24:27], s56 offen offset:0 sc1
    buffer_load_dwordx4 v[164:167], v2, s[24:27], s56 offen offset:1024 sc1
    buffer_load_dwordx4 v[168:171], v2, s[24:27], s56 offen offset:2048 sc1
    buffer_load_dwordx4 v[172:175], v2, s[24:27], s56 offen offset:3072 sc1
    buffer_load_dwordx4 v[176:179], v2, s[24:27], s57 offen offset:0 sc1
    buffer_load_dwordx4 v[180:183], v2, s[24:27], s57 offen offset:1024 sc1
    buffer_load_dwordx4 v[184:187], v2, s[24:27], s57 offen offset:2048 sc1
    buffer_load_dwordx4 v[188:191], v2, s[24:27], s57 offen offset:3072 sc1
    buffer_load_dwordx4 v[192:195], v2, s[24:27], s58 offen offset:0 sc1
    buffer_load_dwordx4 v[196:199], v2, s[24:27], s58 offen offset:1024 sc1
    buffer_load_dwordx4 v[200:203], v2, s[24:27], s58 offen offset:2048 sc1
    buffer_load_dwordx4 v[204:207], v2, s[24:27], s58 offen offset:3072 sc1
    buffer_load_dwordx4 v[224:227], v2, s[24:27], s59 offen offset:0 sc1
    buffer_load_dwordx4 v[228:231], v2, s[24:27], s59 offen offset:1024 sc1
    buffer_load_dwordx4 v[232:235], v2, s[24:27], s59 offen offset:2048 sc1
    buffer_load_dwordx4 v[236:239], v2, s[24:27], s59 offen offset:3072 sc1
    s_waitcnt vmcnt(0)
L_of2_81:
    v_mov_b32 v13, 0
    s_waitcnt vmcnt(4)
    v_max3_u32 v13, v13, v160, v163
    v_max3_u32 v13, v13, v164, v167
    v_max3_u32 v13, v13, v168, v171
    v_max3_u32 v13, v13, v172, v175
    v_max3_u32 v13, v13, v176, v179
    v_max3_u32 v13, v13, v180, v183
    v_max3_u32 v13, v13, v184, v187
    v_max3_u32 v13, v13, v188, v191
    v_max3_u32 v13, v13, v224, v227
    v_max3_u32 v13, v13, v228, v231
    v_max3_u32 v13, v13, v232, v235
    v_max3_u32 v13, v13, v236, v239
    s_waitcnt vmcnt(0)
    v_max3_u32 v13, v13, v192, v195
    v_max3_u32 v13, v13, v196, v199
    v_max3_u32 v13, v13, v200, v203
    v_max3_u32 v13, v13, v204, v207
    v_cmp_eq_u32 vcc, -1, v13
    s_sub_u32 s55, s55, 1
    s_cbranch_scc1 L_ofd_80
    s_nop 2
    s_cbranch_vccz L_ofd_80
    s_branch L_of_79
L_ofd_80:
    v_mfma_f32_32x32x16_bf16 v[144:159], v[160:163], v[20:23], v[144:159]
    v_mfma_f32_32x32x16_bf16 v[128:143], v[160:163], v[16:19], v[128:143]
    v_mfma_f32_32x32x16_bf16 v[144:159], v[164:167], v[28:31], v[144:159]
    v_mfma_f32_32x32x16_bf16 v[128:143], v[164:167], v[24:27], v[128:143]
    v_mfma_f32_32x32x16_bf16 v[144:159], v[168:171], v[36:39], v[144:159]
    v_mfma_f32_32x32x16_bf16 v[128:143], v[168:171], v[32:35], v[128:143]
    v_mfma_f32_32x32x16_bf16 v[144:159], v[172:175], v[44:47], v[144:159]
    v_mfma_f32_32x32x16_bf16 v[128:143], v[172:175], v[40:43], v[128:143]
    v_mfma_f32_32x32x16_bf16 v[144:159], v[176:179], v[52:55], v[144:159]
    v_mfma_f32_32x32x16_bf16 v[128:143], v[176:179], v[48:51], v[128:143]
    v_mfma_f32_32x32x16_bf16 v[144:159], v[180:183], v[60:63], v[144:159]
    v_mfma_f32_32x32x16_bf16 v[128:143], v[180:183], v[56:59], v[128:143]
    v_mfma_f32_32x32x16_bf16 v[144:159], v[184:187], v[68:71], v[144:159]
    v_mfma_f32_32x32x16_bf16 v[128:143], v[184:187], v[64:67], v[128:143]
    v_mfma_f32_32x32x16_bf16 v[144:159], v[188:191], v[76:79], v[144:159]
    v_mfma_f32_32x32x16_bf16 v[128:143], v[188:191], v[72:75], v[128:143]
    v_mfma_f32_32x32x16_bf16 v[144:159], v[192:195], v[84:87], v[144:159]
    v_mfma_f32_32x32x16_bf16 v[128:143], v[192:195], v[80:83], v[128:143]
    v_mfma_f32_32x32x16_bf16 v[144:159], v[196:199], v[92:95], v[144:159]
    v_mfma_f32_32x32x16_bf16 v[128:143], v[196:199], v[88:91], v[128:143]
    v_mfma_f32_32x32x16_bf16 v[144:159], v[200:203], v[100:103], v[144:159]
    v_mfma_f32_32x32x16_bf16 v[128:143], v[200:203], v[96:99], v[128:143]
    v_mfma_f32_32x32x16_bf16 v[144:159], v[204:207], v[108:111], v[144:159]
    v_mfma_f32_32x32x16_bf16 v[128:143], v[204:207], v[104:107], v[128:143]
    v_mfma_f32_32x32x16_bf16 v[144:159], v[224:227], v[116:119], v[144:159]
    v_mfma_f32_32x32x16_bf16 v[128:143], v[224:227], v[112:115], v[128:143]
    v_mfma_f32_32x32x16_bf16 v[144:159], v[228:231], v[124:127], v[144:159]
    v_mfma_f32_32x32x16_bf16 v[128:143], v[228:231], v[120:123], v[128:143]
    v_mfma_f32_32x32x16_bf16 v[144:159], v[232:235], v[212:215], v[144:159]
    v_mfma_f32_32x32x16_bf16 v[128:143], v[232:235], v[208:211], v[128:143]
    v_mfma_f32_32x32x16_bf16 v[144:159], v[236:239], v[220:223], v[144:159]
    v_mfma_f32_32x32x16_bf16 v[128:143], v[236:239], v[216:219], v[128:143]
    v_mov_b32 v12, 159760
    s_mov_b32 s48, 0x400000
L_lw_82:
    ds_read_b32 v13, v12
    s_waitcnt lgkmcnt(0)
    v_readfirstlane_b32 s49, v13
    s_sub_u32 s48, s48, 1
    s_cbranch_scc1 L_lwd_83
    s_cmp_ge_u32 s49, 4
    s_cbranch_scc1 L_lwd_83
    s_branch L_lw_82
L_lwd_83:
    s_xor_b32 s48, s61, 1
    s_lshl_b32 s48, s48, 12
    s_add_u32 s48, s48, 114688
    v_add_u32 v14, s48, v2
    s_nop 7
    ds_write_b128 v14, v[144:147] offset:0
    ds_write_b128 v14, v[148:151] offset:1024
    ds_write_b128 v14, v[152:155] offset:2048
    ds_write_b128 v14, v[156:159] offset:3072
    s_waitcnt lgkmcnt(0)
    v_mov_b32 v12, 159756
    v_mov_b32 v13, 1
    s_mov_b64 exec, 1
    ds_add_u32 v12, v13
    s_mov_b64 exec, -1
    v_mov_b32 v12, 159756
    s_mov_b32 s48, 0x400000
L_lw_84:
    ds_read_b32 v13, v12
    s_waitcnt lgkmcnt(0)
    v_readfirstlane_b32 s49, v13
    s_sub_u32 s48, s48, 1
    s_cbranch_scc1 L_lwd_85
    s_cmp_ge_u32 s49, 4
    s_cbranch_scc1 L_lwd_85
    s_branch L_lw_84
L_lwd_85:
    s_lshl_b32 s48, s61, 12
    s_add_u32 s48, s48, 114688
    v_add_u32 v12, s48, v2
    ds_read_b128 v[16:19], v12 offset:0
    ds_read_b128 v[20:23], v12 offset:1024
    ds_read_b128 v[24:27], v12 offset:2048
    ds_read_b128 v[28:31], v12 offset:3072
    s_waitcnt lgkmcnt(3)
    v_add_f32 v128, v128, v16
    v_add_f32 v129, v129, v17
    v_add_f32 v130, v130, v18
    v_add_f32 v131, v131, v19
    buffer_store_dword v128, v11, s[32:35], s52 offen offset:0
    buffer_store_dword v129, v11, s[32:35], s52 offen offset:1792
    s_add_u32 s52, s52, 3584
    buffer_store_dword v130, v11, s[32:35], s52 offen offset:0
    buffer_store_dword v131, v11, s[32:35], s52 offen offset:1792
    s_waitcnt lgkmcnt(2)
    v_add_f32 v132, v132, v20
    v_add_f32 v133, v133, v21
    v_add_f32 v134, v134, v22
    v_add_f32 v135, v135, v23
    s_add_u32 s52, s52, 3584
    buffer_store_dword v132, v11, s[32:35], s52 offen offset:0
    buffer_store_dword v133, v11, s[32:35], s52 offen offset:1792
    s_add_u32 s52, s52, 3584
    buffer_store_dword v134, v11, s[32:35], s52 offen offset:0
    buffer_store_dword v135, v11, s[32:35], s52 offen offset:1792
    s_waitcnt lgkmcnt(1)
    v_add_f32 v136, v136, v24
    v_add_f32 v137, v137, v25
    v_add_f32 v138, v138, v26
    v_add_f32 v139, v139, v27
    s_add_u32 s52, s52, 3584
    buffer_store_dword v136, v11, s[32:35], s52 offen offset:0
    buffer_store_dword v137, v11, s[32:35], s52 offen offset:1792
    s_add_u32 s52, s52, 3584
    buffer_store_dword v138, v11, s[32:35], s52 offen offset:0
    buffer_store_dword v139, v11, s[32:35], s52 offen offset:1792
    s_waitcnt lgkmcnt(0)
    v_add_f32 v140, v140, v28
    v_add_f32 v141, v141, v29
    v_add_f32 v142, v142, v30
    v_add_f32 v143, v143, v31
    s_add_u32 s52, s52, 3584
    buffer_store_dword v140, v11, s[32:35], s52 offen offset:0
    buffer_store_dword v141, v11, s[32:35], s52 offen offset:1792
    s_add_u32 s52, s52, 3584
    buffer_store_dword v142, v11, s[32:35], s52 offen offset:0
    buffer_store_dword v143, v11, s[32:35], s52 offen offset:1792
    s_endpgm
L_hw7:
    s_cmp_eq_u32 s3, 4
    s_cbranch_scc0 L_nz_86
    v_lshlrev_b32 v12, 2, v1
    v_add_u32 v12, 159744, v12
    ds_write_b32 v12, v247
    v_mov_b32 v12, 159764
    v_mov_b32 v13, 1
    s_mov_b64 exec, 1
    ds_add_u32 v12, v13
    s_mov_b64 exec, -1
    v_mov_b32 v12, 159764
    v_mov_b32 v13, 1
    s_mov_b64 exec, 1
    ds_add_u32 v12, v13
    s_mov_b64 exec, -1
    v_mov_b32 v12, 159764
    v_mov_b32 v13, 1
    s_mov_b64 exec, 1
    ds_add_u32 v12, v13
    s_mov_b64 exec, -1
    v_mov_b32 v12, 159764
    v_mov_b32 v13, 1
    s_mov_b64 exec, 1
    ds_add_u32 v12, v13
    s_mov_b64 exec, -1
L_nz_86:
    v_and_b32 v12, 31, v1
    v_bfe_u32 v13, v12, 2, 1
    v_lshlrev_b32 v13, 4, v13
    v_lshrrev_b32 v14, 3, v12
    v_lshl_add_u32 v13, v14, 2, v13
    v_and_b32 v14, 3, v12
    v_add_u32 v13, v13, v14
    v_mov_b32 v30, v13
    s_sub_u32 s48, s3, 4
    s_lshr_b32 s48, s48, 1
    s_lshl_b32 s48, s48, 5
    v_add_u32 v13, s48, v13
    v_lshrrev_b32 v14, 5, v1
    v_lshrrev_b32 v15, 1, v13
    v_and_b32 v15, 7, v15
    v_lshlrev_b32 v12, 7, v13
    v_xor_b32 v15, v15, v14
    v_xor_b32 v11, 0, v15
    v_lshl_add_u32 v16, v11, 4, v12
    v_xor_b32 v11, 2, v15
    v_lshl_add_u32 v17, v11, 4, v12
    v_xor_b32 v11, 4, v15
    v_lshl_add_u32 v18, v11, 4, v12
    v_xor_b32 v11, 6, v15
    v_lshl_add_u32 v19, v11, 4, v12
    v_lshrrev_b32 v12, 5, v1
    v_mul_u32_u24 v12, 8, v12
    v_bfe_u32 v13, v1, 2, 2
    v_add_u32 v12, v12, v13
    v_mul_u32_u24 v12, 128, v12
    v_bfe_u32 v13, v1, 4, 1
    v_lshl_add_u32 v12, v13, 5, v12
    v_and_b32 v13, 3, v1
    v_lshl_add_u32 v28, v13, 3, v12
    s_and_b32 s48, s3, 1
    s_mul_i32 s48, s48, 56
    s_add_u32 s48, s48, 57344
    v_add_u32 v28, s48, v28
    v_add_u32 v29, 49152, v28
    v_lshrrev_b32 v12, 5, v1
    v_mul_u32_u24 v12, 8, v12
    v_bfe_u32 v13, v1, 2, 2
    v_add_u32 v12, v12, v13
    v_mul_u32_u24 v12, 56, v12
    v_bfe_u32 v13, v1, 4, 1
    v_lshl_add_u32 v12, v13, 5, v12
    v_and_b32 v13, 3, v1
    v_lshl_add_u32 v20, v13, 3, v12
    s_and_b32 s48, s3, 1
    s_lshl_b32 s48, s48, 12
    s_add_u32 s48, s48, 65536
    v_add_u32 v20, s48, v20
    v_add_u32 v21, 49152, v20
    s_bitcmp1_b32 s3, 0
    s_cbranch_scc1 L_hw7v
    s_waitcnt lgkmcnt(0)
    s_barrier
    ds_read_b128 v[64:67], v16 offset:0
    ds_read_b64_tr_b16 v[80:81], v20 offset:0
    ds_read_b64_tr_b16 v[82:83], v20 offset:224
    ds_read_b128 v[68:71], v17 offset:0
    ds_read_b64_tr_b16 v[84:85], v20 offset:896
    ds_read_b64_tr_b16 v[86:87], v20 offset:1120
    ds_read_b128 v[72:75], v18 offset:0
    ds_read_b64_tr_b16 v[88:89], v20 offset:1792
    ds_read_b64_tr_b16 v[90:91], v20 offset:2016
    ds_read_b128 v[76:79], v19 offset:0
    ds_read_b64_tr_b16 v[92:93], v20 offset:2688
    ds_read_b64_tr_b16 v[94:95], v20 offset:2912
    s_waitcnt lgkmcnt(0)
    s_barrier
    v_mfma_f32_32x32x16_bf16 v[32:47], v[80:83], v[64:67], 0
    ds_read_b128 v[128:131], v16 offset:8192
    ds_read_b64_tr_b16 v[144:145], v20 offset:24576
    ds_read_b64_tr_b16 v[146:147], v20 offset:24800
    v_mfma_f32_32x32x16_bf16 v[32:47], v[84:87], v[68:71], v[32:47]
    ds_read_b128 v[132:135], v17 offset:8192
    ds_read_b64_tr_b16 v[148:149], v20 offset:25472
    ds_read_b64_tr_b16 v[150:151], v20 offset:25696
    v_mfma_f32_32x32x16_bf16 v[32:47], v[88:91], v[72:75], v[32:47]
    ds_read_b128 v[136:139], v18 offset:8192
    ds_read_b64_tr_b16 v[152:153], v20 offset:26368
    ds_read_b64_tr_b16 v[154:155], v20 offset:26592
    v_mfma_f32_32x32x16_bf16 v[32:47], v[92:95], v[76:79], v[32:47]
    ds_read_b128 v[140:143], v19 offset:8192
    ds_read_b64_tr_b16 v[156:157], v20 offset:27264
    ds_read_b64_tr_b16 v[158:159], v20 offset:27488
    s_waitcnt lgkmcnt(0)
    s_barrier
    v_mfma_f32_32x32x16_bf16 v[32:47], v[144:147], v[128:131], v[32:47]
    ds_read_b128 v[64:67], v16 offset:16384
    ds_read_b64_tr_b16 v[80:81], v21 offset:0
    ds_read_b64_tr_b16 v[82:83], v21 offset:224
    v_mfma_f32_32x32x16_bf16 v[32:47], v[148:151], v[132:135], v[32:47]
    ds_read_b128 v[68:71], v17 offset:16384
    ds_read_b64_tr_b16 v[84:85], v21 offset:896
    ds_read_b64_tr_b16 v[86:87], v21 offset:1120
    v_mfma_f32_32x32x16_bf16 v[32:47], v[152:155], v[136:139], v[32:47]
    ds_read_b128 v[72:75], v18 offset:16384
    ds_read_b64_tr_b16 v[88:89], v21 offset:1792
    ds_read_b64_tr_b16 v[90:91], v21 offset:2016
    v_mfma_f32_32x32x16_bf16 v[32:47], v[156:159], v[140:143], v[32:47]
    ds_read_b128 v[76:79], v19 offset:16384
    ds_read_b64_tr_b16 v[92:93], v21 offset:2688
    ds_read_b64_tr_b16 v[94:95], v21 offset:2912
    s_waitcnt lgkmcnt(0)
    s_barrier
    v_mfma_f32_32x32x16_bf16 v[32:47], v[80:83], v[64:67], v[32:47]
    ds_read_b128 v[128:131], v16 offset:24576
    ds_read_b64_tr_b16 v[144:145], v21 offset:24576
    ds_read_b64_tr_b16 v[146:147], v21 offset:24800
    v_mfma_f32_32x32x16_bf16 v[32:47], v[84:87], v[68:71], v[32:47]
    ds_read_b128 v[132:135], v17 offset:24576
    ds_read_b64_tr_b16 v[148:149], v21 offset:25472
    ds_read_b64_tr_b16 v[150:151], v21 offset:25696
    v_mfma_f32_32x32x16_bf16 v[32:47], v[88:91], v[72:75], v[32:47]
    ds_read_b128 v[136:139], v18 offset:24576
    ds_read_b64_tr_b16 v[152:153], v21 offset:26368
    ds_read_b64_tr_b16 v[154:155], v21 offset:26592
    v_mfma_f32_32x32x16_bf16 v[32:47], v[92:95], v[76:79], v[32:47]
    ds_read_b128 v[140:143], v19 offset:24576
    ds_read_b64_tr_b16 v[156:157], v21 offset:27264
    ds_read_b64_tr_b16 v[158:159], v21 offset:27488
    s_waitcnt lgkmcnt(0)
    s_barrier
    v_mfma_f32_32x32x16_bf16 v[32:47], v[144:147], v[128:131], v[32:47]
    ds_read_b128 v[64:67], v16 offset:32768
    ds_read_b64_tr_b16 v[80:81], v20 offset:8192
    ds_read_b64_tr_b16 v[82:83], v20 offset:8416
    v_mfma_f32_32x32x16_bf16 v[32:47], v[148:151], v[132:135], v[32:47]
    ds_read_b128 v[68:71], v17 offset:32768
    ds_read_b64_tr_b16 v[84:85], v20 offset:9088
    ds_read_b64_tr_b16 v[86:87], v20 offset:9312
    v_mfma_f32_32x32x16_bf16 v[32:47], v[152:155], v[136:139], v[32:47]
    ds_read_b128 v[72:75], v18 offset:32768
    ds_read_b64_tr_b16 v[88:89], v20 offset:9984
    ds_read_b64_tr_b16 v[90:91], v20 offset:10208
    v_mfma_f32_32x32x16_bf16 v[32:47], v[156:159], v[140:143], v[32:47]
    ds_read_b128 v[76:79], v19 offset:32768
    ds_read_b64_tr_b16 v[92:93], v20 offset:10880
    ds_read_b64_tr_b16 v[94:95], v20 offset:11104
    s_waitcnt lgkmcnt(0)
    s_barrier
    v_mfma_f32_32x32x16_bf16 v[32:47], v[80:83], v[64:67], v[32:47]
    ds_read_b128 v[128:131], v16 offset:40960
    ds_read_b64_tr_b16 v[144:145], v20 offset:32768
    ds_read_b64_tr_b16 v[146:147], v20 offset:32992
    v_mfma_f32_32x32x16_bf16 v[32:47], v[84:87], v[68:71], v[32:47]
    ds_read_b128 v[132:135], v17 offset:40960
    ds_read_b64_tr_b16 v[148:149], v20 offset:33664
    ds_read_b64_tr_b16 v[150:151], v20 offset:33888
    v_mfma_f32_32x32x16_bf16 v[32:47], v[88:91], v[72:75], v[32:47]
    ds_read_b128 v[136:139], v18 offset:40960
    ds_read_b64_tr_b16 v[152:153], v20 offset:34560
    ds_read_b64_tr_b16 v[154:155], v20 offset:34784
    v_mfma_f32_32x32x16_bf16 v[32:47], v[92:95], v[76:79], v[32:47]
    ds_read_b128 v[140:143], v19 offset:40960
    ds_read_b64_tr_b16 v[156:157], v20 offset:35456
    ds_read_b64_tr_b16 v[158:159], v20 offset:35680
    s_waitcnt lgkmcnt(0)
    s_barrier
    v_mfma_f32_32x32x16_bf16 v[32:47], v[144:147], v[128:131], v[32:47]
    ds_read_b128 v[64:67], v16 offset:49152
    ds_read_b64_tr_b16 v[80:81], v21 offset:8192
    ds_read_b64_tr_b16 v[82:83], v21 offset:8416
    v_mfma_f32_32x32x16_bf16 v[32:47], v[148:151], v[132:135], v[32:47]
    ds_read_b128 v[68:71], v17 offset:49152
    ds_read_b64_tr_b16 v[84:85], v21 offset:9088
    ds_read_b64_tr_b16 v[86:87], v21 offset:9312
    v_mfma_f32_32x32x16_bf16 v[32:47], v[152:155], v[136:139], v[32:47]
    ds_read_b128 v[72:75], v18 offset:49152
    ds_read_b64_tr_b16 v[88:89], v21 offset:9984
    ds_read_b64_tr_b16 v[90:91], v21 offset:10208
    v_mfma_f32_32x32x16_bf16 v[32:47], v[156:159], v[140:143], v[32:47]
    ds_read_b128 v[76:79], v19 offset:49152
    ds_read_b64_tr_b16 v[92:93], v21 offset:10880
    ds_read_b64_tr_b16 v[94:95], v21 offset:11104
    s_waitcnt lgkmcnt(0)
    v_mfma_f32_32x32x16_bf16 v[32:47], v[80:83], v[64:67], v[32:47]
    v_mfma_f32_32x32x16_bf16 v[32:47], v[84:87], v[68:71], v[32:47]
    v_mfma_f32_32x32x16_bf16 v[32:47], v[88:91], v[72:75], v[32:47]
    v_mfma_f32_32x32x16_bf16 v[32:47], v[92:95], v[76:79], v[32:47]
    v_mov_b32 v58, 0x3f803f80
    v_mov_b32 v59, 0x3f80
    s_nop 7
    s_nop 5
    v_cvt_pk_bf16_f32 v48, v32, v33
    v_cvt_pk_bf16_f32 v49, v34, v35
    v_cvt_pk_bf16_f32 v50, v36, v37
    v_cvt_pk_bf16_f32 v51, v38, v39
    v_cvt_pk_bf16_f32 v52, v40, v41
    v_cvt_pk_bf16_f32 v53, v42, v43
    v_cvt_pk_bf16_f32 v54, v44, v45
    v_cvt_pk_bf16_f32 v55, v46, v47
    v_cndmask_b32 v62, v54, v247, s[46:47]
    v_cndmask_b32 v63, v55, v247, s[46:47]
    v_cndmask_b32 v54, v54, v58, s[46:47]
    v_cndmask_b32 v55, v55, v59, s[46:47]
    s_sub_u32 s52, s3, 4
    s_lshr_b32 s52, s52, 1
    s_lshl_b32 s53, s4, 1
    s_add_u32 s52, s52, s53
    s_lshl_b32 s52, s52, 12
    s_add_u32 s52, s52, 0
    buffer_store_dwordx4 v[48:51], v2, s[24:27], s52 offen sc1
    buffer_store_dwordx4 v[52:55], v2, s[24:27], s52 offen offset:1024 sc1
    v_dot2_f32_bf16 v56, v62, v62, v247
    v_dot2_f32_bf16 v57, v63, v63, v247
    v_dot2_f32_bf16 v56, v48, v48, v56
    v_dot2_f32_bf16 v57, v49, v49, v57
    v_dot2_f32_bf16 v56, v50, v50, v56
    v_dot2_f32_bf16 v57, v51, v51, v57
    v_dot2_f32_bf16 v56, v52, v52, v56
    v_dot2_f32_bf16 v57, v53, v53, v57
    s_nop 2
    v_add_f32 v56, v56, v57
    v_mov_b32 v57, v56
    s_nop 1
    v_permlane32_swap_b32 v56, v57
    s_nop 1
    v_add_f32 v56, v56, v57
    s_nop 1
    v_max_f32_dpp v56, v56, v56 row_shr:1 row_mask:0xf bank_mask:0xf
    s_nop 1
    v_max_f32_dpp v56, v56, v56 row_shr:2 row_mask:0xf bank_mask:0xf
    s_nop 1
    v_max_f32_dpp v56, v56, v56 row_shr:4 row_mask:0xf bank_mask:0xf
    s_nop 1
    v_max_f32_dpp v56, v56, v56 row_shr:8 row_mask:0xf bank_mask:0xf
    s_nop 1
    v_readlane_b32 s48, v56, 15
    v_readlane_b32 s49, v56, 31
    s_nop 3
    s_max_u32 s48, s48, s49
    v_mov_b32 v60, s48
    s_waitcnt lgkmcnt(0)
    s_barrier
    ds_read_b128 v[64:67], v16 offset:0
    ds_read_b64_tr_b16 v[112:113], v28 offset:0
    ds_read_b64_tr_b16 v[114:115], v28 offset:512
    ds_read_b128 v[68:71], v17 offset:0
    ds_read_b64_tr_b16 v[116:117], v28 offset:2048
    ds_read_b64_tr_b16 v[118:119], v28 offset:2560
    ds_read_b128 v[72:75], v18 offset:0
    ds_read_b64_tr_b16 v[120:121], v28 offset:4096
    ds_read_b64_tr_b16 v[122:123], v28 offset:4608
    ds_read_b128 v[76:79], v19 offset:0
    ds_read_b64_tr_b16 v[124:125], v28 offset:6144
    ds_read_b64_tr_b16 v[126:127], v28 offset:6656
    s_waitcnt vmcnt(0)
    v_mov_b32 v12, 159232
    ds_read_b32 v61, v12
    s_waitcnt lgkmcnt(0)
    s_lshl_b32 s48, s4, 7
    s_sub_u32 s49, s3, 4
    s_lshl_b32 s49, s49, 3
    s_add_u32 s48, s48, s49
    s_add_u32 s48, s48, 540672
    v_lshlrev_b32 v12, 12, v1
    s_mov_b64 exec, 0xff
    buffer_store_dwordx2 v[60:61], v12, s[24:27], s48 offen sc1
    s_mov_b64 exec, -1
    s_waitcnt lgkmcnt(0)
    s_barrier
    v_mfma_f32_32x32x16_bf16 v[192:207], v[112:115], v[64:67], 0
    ds_read_b128 v[128:131], v16 offset:8192
    ds_read_b64_tr_b16 v[176:177], v28 offset:24576
    ds_read_b64_tr_b16 v[178:179], v28 offset:25088
    v_mfma_f32_32x32x16_bf16 v[192:207], v[116:119], v[68:71], v[192:207]
    ds_read_b128 v[132:135], v17 offset:8192
    ds_read_b64_tr_b16 v[180:181], v28 offset:26624
    ds_read_b64_tr_b16 v[182:183], v28 offset:27136
    v_mfma_f32_32x32x16_bf16 v[192:207], v[120:123], v[72:75], v[192:207]
    ds_read_b128 v[136:139], v18 offset:8192
    ds_read_b64_tr_b16 v[184:185], v28 offset:28672
    ds_read_b64_tr_b16 v[186:187], v28 offset:29184
    v_mfma_f32_32x32x16_bf16 v[192:207], v[124:127], v[76:79], v[192:207]
    ds_read_b128 v[140:143], v19 offset:8192
    ds_read_b64_tr_b16 v[188:189], v28 offset:30720
    ds_read_b64_tr_b16 v[190:191], v28 offset:31232
    s_waitcnt lgkmcnt(0)
    s_barrier
    v_mfma_f32_32x32x16_bf16 v[192:207], v[176:179], v[128:131], v[192:207]
    ds_read_b128 v[64:67], v16 offset:16384
    ds_read_b64_tr_b16 v[112:113], v29 offset:0
    ds_read_b64_tr_b16 v[114:115], v29 offset:512
    v_mfma_f32_32x32x16_bf16 v[192:207], v[180:183], v[132:135], v[192:207]
    ds_read_b128 v[68:71], v17 offset:16384
    ds_read_b64_tr_b16 v[116:117], v29 offset:2048
    ds_read_b64_tr_b16 v[118:119], v29 offset:2560
    v_mfma_f32_32x32x16_bf16 v[192:207], v[184:187], v[136:139], v[192:207]
    ds_read_b128 v[72:75], v18 offset:16384
    ds_read_b64_tr_b16 v[120:121], v29 offset:4096
    ds_read_b64_tr_b16 v[122:123], v29 offset:4608
    v_mfma_f32_32x32x16_bf16 v[192:207], v[188:191], v[140:143], v[192:207]
    ds_read_b128 v[76:79], v19 offset:16384
    ds_read_b64_tr_b16 v[124:125], v29 offset:6144
    ds_read_b64_tr_b16 v[126:127], v29 offset:6656
    s_waitcnt lgkmcnt(0)
    s_barrier
    v_mfma_f32_32x32x16_bf16 v[192:207], v[112:115], v[64:67], v[192:207]
    ds_read_b128 v[128:131], v16 offset:24576
    ds_read_b64_tr_b16 v[176:177], v29 offset:24576
    ds_read_b64_tr_b16 v[178:179], v29 offset:25088
    v_mfma_f32_32x32x16_bf16 v[192:207], v[116:119], v[68:71], v[192:207]
    ds_read_b128 v[132:135], v17 offset:24576
    ds_read_b64_tr_b16 v[180:181], v29 offset:26624
    ds_read_b64_tr_b16 v[182:183], v29 offset:27136
    v_mfma_f32_32x32x16_bf16 v[192:207], v[120:123], v[72:75], v[192:207]
    ds_read_b128 v[136:139], v18 offset:24576
    ds_read_b64_tr_b16 v[184:185], v29 offset:28672
    ds_read_b64_tr_b16 v[186:187], v29 offset:29184
    v_mfma_f32_32x32x16_bf16 v[192:207], v[124:127], v[76:79], v[192:207]
    ds_read_b128 v[140:143], v19 offset:24576
    ds_read_b64_tr_b16 v[188:189], v29 offset:30720
    ds_read_b64_tr_b16 v[190:191], v29 offset:31232
    s_waitcnt lgkmcnt(0)
    s_barrier
    v_mfma_f32_32x32x16_bf16 v[192:207], v[176:179], v[128:131], v[192:207]
    ds_read_b128 v[64:67], v16 offset:32768
    ds_read_b64_tr_b16 v[112:113], v28 offset:0
    ds_read_b64_tr_b16 v[114:115], v28 offset:512
    v_mfma_f32_32x32x16_bf16 v[192:207], v[180:183], v[132:135], v[192:207]
    ds_read_b128 v[68:71], v17 offset:32768
    ds_read_b64_tr_b16 v[116:117], v28 offset:2048
    ds_read_b64_tr_b16 v[118:119], v28 offset:2560
    v_mfma_f32_32x32x16_bf16 v[192:207], v[184:187], v[136:139], v[192:207]
    ds_read_b128 v[72:75], v18 offset:32768
    ds_read_b64_tr_b16 v[120:121], v28 offset:4096
    ds_read_b64_tr_b16 v[122:123], v28 offset:4608
    v_mfma_f32_32x32x16_bf16 v[192:207], v[188:191], v[140:143], v[192:207]
    ds_read_b128 v[76:79], v19 offset:32768
    ds_read_b64_tr_b16 v[124:125], v28 offset:6144
    ds_read_b64_tr_b16 v[126:127], v28 offset:6656
    s_waitcnt lgkmcnt(0)
    s_barrier
    v_mfma_f32_32x32x16_bf16 v[192:207], v[112:115], v[64:67], v[192:207]
    ds_read_b128 v[128:131], v16 offset:40960
    ds_read_b64_tr_b16 v[176:177], v28 offset:24576
    ds_read_b64_tr_b16 v[178:179], v28 offset:25088
    v_mfma_f32_32x32x16_bf16 v[192:207], v[116:119], v[68:71], v[192:207]
    ds_read_b128 v[132:135], v17 offset:40960
    ds_read_b64_tr_b16 v[180:181], v28 offset:26624
    ds_read_b64_tr_b16 v[182:183], v28 offset:27136
    v_mfma_f32_32x32x16_bf16 v[192:207], v[120:123], v[72:75], v[192:207]
    ds_read_b128 v[136:139], v18 offset:40960
    ds_read_b64_tr_b16 v[184:185], v28 offset:28672
    ds_read_b64_tr_b16 v[186:187], v28 offset:29184
    v_mfma_f32_32x32x16_bf16 v[192:207], v[124:127], v[76:79], v[192:207]
    ds_read_b128 v[140:143], v19 offset:40960
    ds_read_b64_tr_b16 v[188:189], v28 offset:30720
    ds_read_b64_tr_b16 v[190:191], v28 offset:31232
    s_waitcnt lgkmcnt(0)
    s_barrier
    v_mfma_f32_32x32x16_bf16 v[192:207], v[176:179], v[128:131], v[192:207]
    ds_read_b128 v[64:67], v16 offset:49152
    ds_read_b64_tr_b16 v[112:113], v29 offset:0
    ds_read_b64_tr_b16 v[114:115], v29 offset:512
    v_mfma_f32_32x32x16_bf16 v[192:207], v[180:183], v[132:135], v[192:207]
    ds_read_b128 v[68:71], v17 offset:49152
    ds_read_b64_tr_b16 v[116:117], v29 offset:2048
    ds_read_b64_tr_b16 v[118:119], v29 offset:2560
    v_mfma_f32_32x32x16_bf16 v[192:207], v[184:187], v[136:139], v[192:207]
    ds_read_b128 v[72:75], v18 offset:49152
    ds_read_b64_tr_b16 v[120:121], v29 offset:4096
    ds_read_b64_tr_b16 v[122:123], v29 offset:4608
    v_mfma_f32_32x32x16_bf16 v[192:207], v[188:191], v[140:143], v[192:207]
    ds_read_b128 v[76:79], v19 offset:49152
    ds_read_b64_tr_b16 v[124:125], v29 offset:6144
    ds_read_b64_tr_b16 v[126:127], v29 offset:6656
    s_waitcnt lgkmcnt(0)
    v_mfma_f32_32x32x16_bf16 v[192:207], v[112:115], v[64:67], v[192:207]
    v_mfma_f32_32x32x16_bf16 v[192:207], v[116:119], v[68:71], v[192:207]
    v_mfma_f32_32x32x16_bf16 v[192:207], v[120:123], v[72:75], v[192:207]
    v_mfma_f32_32x32x16_bf16 v[192:207], v[124:127], v[76:79], v[192:207]
    s_branch L_hw7d
L_hw7v:
    s_waitcnt lgkmcnt(0)
    s_barrier
    ds_read_b128 v[64:67], v16 offset:0
    ds_read_b64_tr_b16 v[80:81], v20 offset:0
    ds_read_b64_tr_b16 v[82:83], v20 offset:224
    ds_read_b128 v[68:71], v17 offset:0
    ds_read_b64_tr_b16 v[84:85], v20 offset:896
    ds_read_b64_tr_b16 v[86:87], v20 offset:1120
    ds_read_b128 v[72:75], v18 offset:0
    ds_read_b64_tr_b16 v[88:89], v20 offset:1792
    ds_read_b64_tr_b16 v[90:91], v20 offset:2016
    ds_read_b128 v[76:79], v19 offset:0
    ds_read_b64_tr_b16 v[92:93], v20 offset:2688
    ds_read_b64_tr_b16 v[94:95], v20 offset:2912
    s_waitcnt lgkmcnt(0)
    s_barrier
    v_mfma_f32_32x32x16_bf16 v[32:47], v[64:67], v[80:83], 0
    ds_read_b128 v[128:131], v16 offset:8192
    ds_read_b64_tr_b16 v[144:145], v20 offset:24576
    ds_read_b64_tr_b16 v[146:147], v20 offset:24800
    v_mfma_f32_32x32x16_bf16 v[32:47], v[68:71], v[84:87], v[32:47]
    ds_read_b128 v[132:135], v17 offset:8192
    ds_read_b64_tr_b16 v[148:149], v20 offset:25472
    ds_read_b64_tr_b16 v[150:151], v20 offset:25696
    v_mfma_f32_32x32x16_bf16 v[32:47], v[72:75], v[88:91], v[32:47]
    ds_read_b128 v[136:139], v18 offset:8192
    ds_read_b64_tr_b16 v[152:153], v20 offset:26368
    ds_read_b64_tr_b16 v[154:155], v20 offset:26592
    v_mfma_f32_32x32x16_bf16 v[32:47], v[76:79], v[92:95], v[32:47]
    ds_read_b128 v[140:143], v19 offset:8192
    ds_read_b64_tr_b16 v[156:157], v20 offset:27264
    ds_read_b64_tr_b16 v[158:159], v20 offset:27488
    s_waitcnt lgkmcnt(0)
    s_barrier
    v_mfma_f32_32x32x16_bf16 v[32:47], v[128:131], v[144:147], v[32:47]
    ds_read_b128 v[64:67], v16 offset:16384
    ds_read_b64_tr_b16 v[80:81], v21 offset:0
    ds_read_b64_tr_b16 v[82:83], v21 offset:224
    v_mfma_f32_32x32x16_bf16 v[32:47], v[132:135], v[148:151], v[32:47]
    ds_read_b128 v[68:71], v17 offset:16384
    ds_read_b64_tr_b16 v[84:85], v21 offset:896
    ds_read_b64_tr_b16 v[86:87], v21 offset:1120
    v_mfma_f32_32x32x16_bf16 v[32:47], v[136:139], v[152:155], v[32:47]
    ds_read_b128 v[72:75], v18 offset:16384
    ds_read_b64_tr_b16 v[88:89], v21 offset:1792
    ds_read_b64_tr_b16 v[90:91], v21 offset:2016
    v_mfma_f32_32x32x16_bf16 v[32:47], v[140:143], v[156:159], v[32:47]
    ds_read_b128 v[76:79], v19 offset:16384
    ds_read_b64_tr_b16 v[92:93], v21 offset:2688
    ds_read_b64_tr_b16 v[94:95], v21 offset:2912
    s_waitcnt lgkmcnt(0)
    s_barrier
    v_mfma_f32_32x32x16_bf16 v[32:47], v[64:67], v[80:83], v[32:47]
    ds_read_b128 v[128:131], v16 offset:24576
    ds_read_b64_tr_b16 v[144:145], v21 offset:24576
    ds_read_b64_tr_b16 v[146:147], v21 offset:24800
    v_mfma_f32_32x32x16_bf16 v[32:47], v[68:71], v[84:87], v[32:47]
    ds_read_b128 v[132:135], v17 offset:24576
    ds_read_b64_tr_b16 v[148:149], v21 offset:25472
    ds_read_b64_tr_b16 v[150:151], v21 offset:25696
    v_mfma_f32_32x32x16_bf16 v[32:47], v[72:75], v[88:91], v[32:47]
    ds_read_b128 v[136:139], v18 offset:24576
    ds_read_b64_tr_b16 v[152:153], v21 offset:26368
    ds_read_b64_tr_b16 v[154:155], v21 offset:26592
    v_mfma_f32_32x32x16_bf16 v[32:47], v[76:79], v[92:95], v[32:47]
    ds_read_b128 v[140:143], v19 offset:24576
    ds_read_b64_tr_b16 v[156:157], v21 offset:27264
    ds_read_b64_tr_b16 v[158:159], v21 offset:27488
    s_waitcnt lgkmcnt(0)
    s_barrier
    v_mfma_f32_32x32x16_bf16 v[32:47], v[128:131], v[144:147], v[32:47]
    ds_read_b128 v[64:67], v16 offset:32768
    ds_read_b64_tr_b16 v[80:81], v20 offset:8192
    ds_read_b64_tr_b16 v[82:83], v20 offset:8416
    v_mfma_f32_32x32x16_bf16 v[32:47], v[132:135], v[148:151], v[32:47]
    ds_read_b128 v[68:71], v17 offset:32768
    ds_read_b64_tr_b16 v[84:85], v20 offset:9088
    ds_read_b64_tr_b16 v[86:87], v20 offset:9312
    v_mfma_f32_32x32x16_bf16 v[32:47], v[136:139], v[152:155], v[32:47]
    ds_read_b128 v[72:75], v18 offset:32768
    ds_read_b64_tr_b16 v[88:89], v20 offset:9984
    ds_read_b64_tr_b16 v[90:91], v20 offset:10208
    v_mfma_f32_32x32x16_bf16 v[32:47], v[140:143], v[156:159], v[32:47]
    ds_read_b128 v[76:79], v19 offset:32768
    ds_read_b64_tr_b16 v[92:93], v20 offset:10880
    ds_read_b64_tr_b16 v[94:95], v20 offset:11104
    s_waitcnt lgkmcnt(0)
    s_barrier
    v_mfma_f32_32x32x16_bf16 v[32:47], v[64:67], v[80:83], v[32:47]
    ds_read_b128 v[128:131], v16 offset:40960
    ds_read_b64_tr_b16 v[144:145], v20 offset:32768
    ds_read_b64_tr_b16 v[146:147], v20 offset:32992
    v_mfma_f32_32x32x16_bf16 v[32:47], v[68:71], v[84:87], v[32:47]
    ds_read_b128 v[132:135], v17 offset:40960
    ds_read_b64_tr_b16 v[148:149], v20 offset:33664
    ds_read_b64_tr_b16 v[150:151], v20 offset:33888
    v_mfma_f32_32x32x16_bf16 v[32:47], v[72:75], v[88:91], v[32:47]
    ds_read_b128 v[136:139], v18 offset:40960
    ds_read_b64_tr_b16 v[152:153], v20 offset:34560
    ds_read_b64_tr_b16 v[154:155], v20 offset:34784
    v_mfma_f32_32x32x16_bf16 v[32:47], v[76:79], v[92:95], v[32:47]
    ds_read_b128 v[140:143], v19 offset:40960
    ds_read_b64_tr_b16 v[156:157], v20 offset:35456
    ds_read_b64_tr_b16 v[158:159], v20 offset:35680
    s_waitcnt lgkmcnt(0)
    s_barrier
    v_mfma_f32_32x32x16_bf16 v[32:47], v[128:131], v[144:147], v[32:47]
    ds_read_b128 v[64:67], v16 offset:49152
    ds_read_b64_tr_b16 v[80:81], v21 offset:8192
    ds_read_b64_tr_b16 v[82:83], v21 offset:8416
    v_mfma_f32_32x32x16_bf16 v[32:47], v[132:135], v[148:151], v[32:47]
    ds_read_b128 v[68:71], v17 offset:49152
    ds_read_b64_tr_b16 v[84:85], v21 offset:9088
    ds_read_b64_tr_b16 v[86:87], v21 offset:9312
    v_mfma_f32_32x32x16_bf16 v[32:47], v[136:139], v[152:155], v[32:47]
    ds_read_b128 v[72:75], v18 offset:49152
    ds_read_b64_tr_b16 v[88:89], v21 offset:9984
    ds_read_b64_tr_b16 v[90:91], v21 offset:10208
    v_mfma_f32_32x32x16_bf16 v[32:47], v[140:143], v[156:159], v[32:47]
    ds_read_b128 v[76:79], v19 offset:49152
    ds_read_b64_tr_b16 v[92:93], v21 offset:10880
    ds_read_b64_tr_b16 v[94:95], v21 offset:11104
    s_waitcnt lgkmcnt(0)
    v_mfma_f32_32x32x16_bf16 v[32:47], v[64:67], v[80:83], v[32:47]
    v_mfma_f32_32x32x16_bf16 v[32:47], v[68:71], v[84:87], v[32:47]
    v_mfma_f32_32x32x16_bf16 v[32:47], v[72:75], v[88:91], v[32:47]
    v_mfma_f32_32x32x16_bf16 v[32:47], v[76:79], v[92:95], v[32:47]
    s_mov_b32 s48, 0x10000000
    s_mov_b32 s49, 0x10000000
    s_mov_b32 s50, 0xe0000000
    s_mov_b32 s51, 0xe0000000
    v_mov_b32 v58, 0x3f803f80
    s_nop 7
    s_nop 5
    v_cvt_pk_bf16_f32 v48, v32, v33
    v_cvt_pk_bf16_f32 v49, v34, v35
    v_cvt_pk_bf16_f32 v50, v36, v37
    v_cvt_pk_bf16_f32 v51, v38, v39
    v_cvt_pk_bf16_f32 v52, v40, v41
    v_cvt_pk_bf16_f32 v53, v42, v43
    v_cvt_pk_bf16_f32 v54, v44, v45
    v_cvt_pk_bf16_f32 v55, v46, v47
    v_cndmask_b32 v48, v48, v58, s[48:49]
    v_cndmask_b32 v48, v48, v247, s[50:51]
    v_cndmask_b32 v49, v49, v58, s[48:49]
    v_cndmask_b32 v49, v49, v247, s[50:51]
    v_cndmask_b32 v50, v50, v58, s[48:49]
    v_cndmask_b32 v50, v50, v247, s[50:51]
    v_cndmask_b32 v51, v51, v58, s[48:49]
    v_cndmask_b32 v51, v51, v247, s[50:51]
    v_cndmask_b32 v52, v52, v58, s[48:49]
    v_cndmask_b32 v52, v52, v247, s[50:51]
    v_cndmask_b32 v53, v53, v58, s[48:49]
    v_cndmask_b32 v53, v53, v247, s[50:51]
    v_cndmask_b32 v54, v54, v58, s[48:49]
    v_cndmask_b32 v54, v54, v247, s[50:51]
    v_cndmask_b32 v55, v55, v58, s[48:49]
    v_cndmask_b32 v55, v55, v247, s[50:51]
    s_sub_u32 s52, s3, 4
    s_lshr_b32 s52, s52, 1
    s_lshl_b32 s53, s4, 1
    s_add_u32 s52, s52, s53
    s_lshl_b32 s52, s52, 12
    s_add_u32 s52, s52, 2048
    buffer_store_dwordx4 v[48:51], v2, s[24:27], s52 offen sc1
    buffer_store_dwordx4 v[52:55], v2, s[24:27], s52 offen offset:1024 sc1
    v_mov_b32 v60, 0
    s_waitcnt lgkmcnt(0)
    s_barrier
    ds_read_b128 v[64:67], v16 offset:0
    ds_read_b64_tr_b16 v[112:113], v28 offset:0
    ds_read_b64_tr_b16 v[114:115], v28 offset:512
    ds_read_b128 v[68:71], v17 offset:0
    ds_read_b64_tr_b16 v[116:117], v28 offset:2048
    ds_read_b64_tr_b16 v[118:119], v28 offset:2560
    ds_read_b128 v[72:75], v18 offset:0
    ds_read_b64_tr_b16 v[120:121], v28 offset:4096
    ds_read_b64_tr_b16 v[122:123], v28 offset:4608
    ds_read_b128 v[76:79], v19 offset:0
    ds_read_b64_tr_b16 v[124:125], v28 offset:6144
    ds_read_b64_tr_b16 v[126:127], v28 offset:6656
    s_waitcnt vmcnt(0)
    v_mov_b32 v12, 159232
    ds_read_b32 v61, v12
    s_waitcnt lgkmcnt(0)
    s_lshl_b32 s48, s4, 7
    s_sub_u32 s49, s3, 4
    s_lshl_b32 s49, s49, 3
    s_add_u32 s48, s48, s49
    s_add_u32 s48, s48, 540672
    v_lshlrev_b32 v12, 12, v1
    s_mov_b64 exec, 0xff
    buffer_store_dwordx2 v[60:61], v12, s[24:27], s48 offen sc1
    s_mov_b64 exec, -1
    s_waitcnt lgkmcnt(0)
    s_barrier
    v_mfma_f32_32x32x16_bf16 v[192:207], v[112:115], v[64:67], 0
    ds_read_b128 v[128:131], v16 offset:8192
    ds_read_b64_tr_b16 v[176:177], v28 offset:24576
    ds_read_b64_tr_b16 v[178:179], v28 offset:25088
    v_mfma_f32_32x32x16_bf16 v[192:207], v[116:119], v[68:71], v[192:207]
    ds_read_b128 v[132:135], v17 offset:8192
    ds_read_b64_tr_b16 v[180:181], v28 offset:26624
    ds_read_b64_tr_b16 v[182:183], v28 offset:27136
    v_mfma_f32_32x32x16_bf16 v[192:207], v[120:123], v[72:75], v[192:207]
    ds_read_b128 v[136:139], v18 offset:8192
    ds_read_b64_tr_b16 v[184:185], v28 offset:28672
    ds_read_b64_tr_b16 v[186:187], v28 offset:29184
    v_mfma_f32_32x32x16_bf16 v[192:207], v[124:127], v[76:79], v[192:207]
    ds_read_b128 v[140:143], v19 offset:8192
    ds_read_b64_tr_b16 v[188:189], v28 offset:30720
    ds_read_b64_tr_b16 v[190:191], v28 offset:31232
    s_waitcnt lgkmcnt(0)
    s_barrier
    v_mfma_f32_32x32x16_bf16 v[192:207], v[176:179], v[128:131], v[192:207]
    ds_read_b128 v[64:67], v16 offset:16384
    ds_read_b64_tr_b16 v[112:113], v29 offset:0
    ds_read_b64_tr_b16 v[114:115], v29 offset:512
    v_mfma_f32_32x32x16_bf16 v[192:207], v[180:183], v[132:135], v[192:207]
    ds_read_b128 v[68:71], v17 offset:16384
    ds_read_b64_tr_b16 v[116:117], v29 offset:2048
    ds_read_b64_tr_b16 v[118:119], v29 offset:2560
    v_mfma_f32_32x32x16_bf16 v[192:207], v[184:187], v[136:139], v[192:207]
    ds_read_b128 v[72:75], v18 offset:16384
    ds_read_b64_tr_b16 v[120:121], v29 offset:4096
    ds_read_b64_tr_b16 v[122:123], v29 offset:4608
    v_mfma_f32_32x32x16_bf16 v[192:207], v[188:191], v[140:143], v[192:207]
    ds_read_b128 v[76:79], v19 offset:16384
    ds_read_b64_tr_b16 v[124:125], v29 offset:6144
    ds_read_b64_tr_b16 v[126:127], v29 offset:6656
    s_waitcnt lgkmcnt(0)
    s_barrier
    v_mfma_f32_32x32x16_bf16 v[192:207], v[112:115], v[64:67], v[192:207]
    ds_read_b128 v[128:131], v16 offset:24576
    ds_read_b64_tr_b16 v[176:177], v29 offset:24576
    ds_read_b64_tr_b16 v[178:179], v29 offset:25088
    v_mfma_f32_32x32x16_bf16 v[192:207], v[116:119], v[68:71], v[192:207]
    ds_read_b128 v[132:135], v17 offset:24576
    ds_read_b64_tr_b16 v[180:181], v29 offset:26624
    ds_read_b64_tr_b16 v[182:183], v29 offset:27136
    v_mfma_f32_32x32x16_bf16 v[192:207], v[120:123], v[72:75], v[192:207]
    ds_read_b128 v[136:139], v18 offset:24576
    ds_read_b64_tr_b16 v[184:185], v29 offset:28672
    ds_read_b64_tr_b16 v[186:187], v29 offset:29184
    v_mfma_f32_32x32x16_bf16 v[192:207], v[124:127], v[76:79], v[192:207]
    ds_read_b128 v[140:143], v19 offset:24576
    ds_read_b64_tr_b16 v[188:189], v29 offset:30720
    ds_read_b64_tr_b16 v[190:191], v29 offset:31232
    s_waitcnt lgkmcnt(0)
    s_barrier
    v_mfma_f32_32x32x16_bf16 v[192:207], v[176:179], v[128:131], v[192:207]
    ds_read_b128 v[64:67], v16 offset:32768
    ds_read_b64_tr_b16 v[112:113], v28 offset:0
    ds_read_b64_tr_b16 v[114:115], v28 offset:512
    v_mfma_f32_32x32x16_bf16 v[192:207], v[180:183], v[132:135], v[192:207]
    ds_read_b128 v[68:71], v17 offset:32768
    ds_read_b64_tr_b16 v[116:117], v28 offset:2048
    ds_read_b64_tr_b16 v[118:119], v28 offset:2560
    v_mfma_f32_32x32x16_bf16 v[192:207], v[184:187], v[136:139], v[192:207]
    ds_read_b128 v[72:75], v18 offset:32768
    ds_read_b64_tr_b16 v[120:121], v28 offset:4096
    ds_read_b64_tr_b16 v[122:123], v28 offset:4608
    v_mfma_f32_32x32x16_bf16 v[192:207], v[188:191], v[140:143], v[192:207]
    ds_read_b128 v[76:79], v19 offset:32768
    ds_read_b64_tr_b16 v[124:125], v28 offset:6144
    ds_read_b64_tr_b16 v[126:127], v28 offset:6656
    s_waitcnt lgkmcnt(0)
    s_barrier
    v_mfma_f32_32x32x16_bf16 v[192:207], v[112:115], v[64:67], v[192:207]
    ds_read_b128 v[128:131], v16 offset:40960
    ds_read_b64_tr_b16 v[176:177], v28 offset:24576
    ds_read_b64_tr_b16 v[178:179], v28 offset:25088
    v_mfma_f32_32x32x16_bf16 v[192:207], v[116:119], v[68:71], v[192:207]
    ds_read_b128 v[132:135], v17 offset:40960
    ds_read_b64_tr_b16 v[180:181], v28 offset:26624
    ds_read_b64_tr_b16 v[182:183], v28 offset:27136
    v_mfma_f32_32x32x16_bf16 v[192:207], v[120:123], v[72:75], v[192:207]
    ds_read_b128 v[136:139], v18 offset:40960
    ds_read_b64_tr_b16 v[184:185], v28 offset:28672
    ds_read_b64_tr_b16 v[186:187], v28 offset:29184
    v_mfma_f32_32x32x16_bf16 v[192:207], v[124:127], v[76:79], v[192:207]
    ds_read_b128 v[140:143], v19 offset:40960
    ds_read_b64_tr_b16 v[188:189], v28 offset:30720
    ds_read_b64_tr_b16 v[190:191], v28 offset:31232
    s_waitcnt lgkmcnt(0)
    s_barrier
    v_mfma_f32_32x32x16_bf16 v[192:207], v[176:179], v[128:131], v[192:207]
    ds_read_b128 v[64:67], v16 offset:49152
    ds_read_b64_tr_b16 v[112:113], v29 offset:0
    ds_read_b64_tr_b16 v[114:115], v29 offset:512
    v_mfma_f32_32x32x16_bf16 v[192:207], v[180:183], v[132:135], v[192:207]
    ds_read_b128 v[68:71], v17 offset:49152
    ds_read_b64_tr_b16 v[116:117], v29 offset:2048
    ds_read_b64_tr_b16 v[118:119], v29 offset:2560
    v_mfma_f32_32x32x16_bf16 v[192:207], v[184:187], v[136:139], v[192:207]
    ds_read_b128 v[72:75], v18 offset:49152
    ds_read_b64_tr_b16 v[120:121], v29 offset:4096
    ds_read_b64_tr_b16 v[122:123], v29 offset:4608
    v_mfma_f32_32x32x16_bf16 v[192:207], v[188:191], v[140:143], v[192:207]
    ds_read_b128 v[76:79], v19 offset:49152
    ds_read_b64_tr_b16 v[124:125], v29 offset:6144
    ds_read_b64_tr_b16 v[126:127], v29 offset:6656
    s_waitcnt lgkmcnt(0)
    v_mfma_f32_32x32x16_bf16 v[192:207], v[112:115], v[64:67], v[192:207]
    v_mfma_f32_32x32x16_bf16 v[192:207], v[116:119], v[68:71], v[192:207]
    v_mfma_f32_32x32x16_bf16 v[192:207], v[120:123], v[72:75], v[192:207]
    v_mfma_f32_32x32x16_bf16 v[192:207], v[124:127], v[76:79], v[192:207]
L_hw7d:
    s_mov_b32 s48, 0x3e8b97f6
    s_nop 7
    s_nop 5
    v_mov_b32 v236, v204
    v_mul_f32 v192, s48, v192
    v_mul_f32 v193, s48, v193
    v_mul_f32 v194, s48, v194
    v_mul_f32 v195, s48, v195
    v_mul_f32 v196, s48, v196
    v_mul_f32 v197, s48, v197
    v_mul_f32 v198, s48, v198
    v_mul_f32 v199, s48, v199
    v_mul_f32 v200, s48, v200
    v_mul_f32 v201, s48, v201
    v_mul_f32 v202, s48, v202
    v_mul_f32 v203, s48, v203
    v_mul_f32 v204, s48, v204
    v_mul_f32 v205, s48, v205
    v_mul_f32 v206, s48, v206
    v_mul_f32 v207, s48, v207
    v_cvt_pk_bf16_f32 v224, v192, v193
    v_cvt_pk_bf16_f32 v225, v194, v195
    v_cvt_pk_bf16_f32 v226, v196, v197
    v_cvt_pk_bf16_f32 v227, v198, v199
    v_cvt_pk_bf16_f32 v228, v200, v201
    v_cvt_pk_bf16_f32 v229, v202, v203
    v_cvt_pk_bf16_f32 v230, v204, v205
    v_cvt_pk_bf16_f32 v231, v206, v207
    v_cndmask_b32 v230, v230, v247, s[46:47]
    v_cndmask_b32 v231, v231, v247, s[46:47]
    s_sub_u32 s48, s3, 4
    s_lshl_b32 s48, s48, 11
    s_add_u32 s48, s48, 57344
    v_add_u32 v12, s48, v2
    ds_write_b128 v12, v[224:227]
    s_mov_b32 s50, 0xbfb8aa3b
    v_mul_f32 v236, s50, v236
    v_exp_f32 v236, v236
    v_dot2_f32_bf16 v232, v224, v224, v247
    v_dot2_f32_bf16 v233, v225, v225, v247
    v_dot2_f32_bf16 v232, v226, v226, v232
    v_dot2_f32_bf16 v233, v227, v227, v233
    v_dot2_f32_bf16 v232, v228, v228, v232
    v_dot2_f32_bf16 v233, v229, v229, v233
    v_dot2_f32_bf16 v232, v230, v230, v232
    v_dot2_f32_bf16 v233, v231, v231, v233
    s_nop 2
    v_add_f32 v232, v232, v233
    v_mov_b32 v233, v232
    s_nop 1
    v_permlane32_swap_b32 v232, v233
    s_nop 1
    v_add_f32 v232, v232, v233
    v_add_f32 v236, 1.0, v236
    v_sqrt_f32 v232, v232
    v_rcp_f32 v236, v236
    s_mov_b32 s48, 0x3f820000
    v_mul_f32 v232, s48, v232
    v_cvt_pk_bf16_f32 v234, v232, v247
    v_cndmask_b32 v230, v230, v234, s[46:47]
    ds_write_b128 v12, v[228:231] offset:1024
    s_bitcmp1_b32 s3, 0
    s_cbranch_scc0 L_nog_87
    s_sub_u32 s48, s3, 4
    s_lshr_b32 s48, s48, 1
    s_lshl_b32 s48, s48, 7
    s_add_u32 s48, s48, 155648
    v_lshlrev_b32 v13, 2, v30
    v_add_u32 v13, s48, v13
    s_mov_b64 exec, s[46:47]
    ds_write_b32 v13, v236
    s_mov_b64 exec, -1
L_nog_87:
    s_waitcnt vmcnt(0) lgkmcnt(0)
    v_mov_b32 v12, 159820
    v_mov_b32 v13, 1
    s_mov_b64 exec, 1
    ds_add_u32 v12, v13
    s_mov_b64 exec, -1
    s_barrier
    v_mov_b32 v12, 159232
    ds_read_b32 v13, v12
    s_waitcnt lgkmcnt(0)
    v_readfirstlane_b32 s6, v13
    s_sub_u32 s61, s3, 4
    v_mov_b32 v12, 159800
    s_mov_b32 s48, 0x400000
L_lw_88:
    ds_read_b32 v13, v12
    s_waitcnt lgkmcnt(0)
    v_readfirstlane_b32 s49, v13
    s_sub_u32 s48, s48, 1
    s_cbranch_scc1 L_lwd_89
    s_cmp_ge_u32 s49, 2
    s_cbranch_scc1 L_lwd_89
    s_sleep 2
    s_branch L_lw_88
L_lwd_89:
    v_lshrrev_b32 v12, 5, v1
    v_mul_u32_u24 v12, 4, v12
    v_bfe_u32 v13, v1, 2, 2
    v_add_u32 v12, v12, v13
    v_mul_u32_u24 v12, 1024, v12
    v_bfe_u32 v13, v1, 4, 1
    v_lshl_add_u32 v12, v13, 5, v12
    v_and_b32 v13, 3, v1
    v_lshl_add_u32 v16, v13, 3, v12
    s_lshl_b32 s48, s61, 7
    s_add_u32 s48, s48, 65536
    v_add_u32 v16, s48, v16
    ds_read_b64_tr_b16 v[32:33], v16 offset:0
    ds_read_b64_tr_b16 v[34:35], v16 offset:24576
    ds_read_b64_tr_b16 v[36:37], v16 offset:64
    ds_read_b64_tr_b16 v[38:39], v16 offset:24640
    s_add_u32 s48, s61, 0
    s_lshl_b32 s48, s48, 5
    s_add_u32 s48, s48, s4
    s_lshl_b32 s48, s48, 11
    s_add_u32 s48, s48, 6815744
    s_waitcnt lgkmcnt(0)
    buffer_store_dwordx4 v[32:35], v2, s[24:27], s48 offen offset:0 sc1
    buffer_store_dwordx4 v[36:39], v2, s[24:27], s48 offen offset:1024 sc1
    s_cmp_eq_u32 s61, 3
    s_cbranch_scc1 L_w7s_91
    ds_read_b64_tr_b16 v[40:41], v16 offset:512
    ds_read_b64_tr_b16 v[42:43], v16 offset:25088
    ds_read_b64_tr_b16 v[44:45], v16 offset:576
    ds_read_b64_tr_b16 v[46:47], v16 offset:25152
    s_add_u32 s48, s61, 4
    s_lshl_b32 s48, s48, 5
    s_add_u32 s48, s48, s4
    s_lshl_b32 s48, s48, 11
    s_add_u32 s48, s48, 6815744
    s_waitcnt lgkmcnt(0)
    buffer_store_dwordx4 v[40:43], v2, s[24:27], s48 offen offset:0 sc1
    buffer_store_dwordx4 v[44:47], v2, s[24:27], s48 offen offset:1024 sc1
L_w7s_91:
    s_waitcnt vmcnt(0)
    s_lshl_b32 s48, s4, 2
    s_add_u32 s48, s48, s61
    s_lshl_b32 s48, s48, 2
    s_add_u32 s48, s48, 573440
    v_mov_b32 v12, s48
    v_mov_b32 v13, s6
    s_mov_b64 exec, 1
    buffer_store_dword v13, v12, s[24:27], 0 offen sc1
    s_mov_b64 exec, -1
    v_mov_b32 v12, 159772
    s_mov_b32 s48, 0x400000
L_lw_92:
    ds_read_b32 v13, v12
    s_waitcnt lgkmcnt(0)
    v_readfirstlane_b32 s49, v13
    s_sub_u32 s48, s48, 1
    s_cbranch_scc1 L_lwd_93
    s_cmp_ge_u32 s49, 256
    s_cbranch_scc1 L_lwd_93
    s_sleep 16
    s_branch L_lw_92
L_lwd_93:
    v_lshlrev_b32 v12, 2, v1
    s_mov_b32 s48, 0x10000
    s_mov_b32 s50, 573440
L_w7f_94:
    buffer_load_dword v13, v12, s[24:27], s50 offen sc1
    buffer_load_dword v14, v12, s[24:27], s50 offen offset:256 sc1
    s_waitcnt vmcnt(0)
    v_xor_b32 v13, s6, v13
    v_xor_b32 v14, s6, v14
    v_or_b32 v13, v13, v14
    v_cmp_ne_u32 vcc, 0, v13
    s_sub_u32 s48, s48, 1
    s_cbranch_scc1 L_w7fd_95
    s_nop 2
    s_cbranch_vccz L_w7fd_95
    s_sleep 16
    s_branch L_w7f_94
L_w7fd_95:
    s_and_b32 s48, s4, 7
    s_lshl_b32 s48, s48, 2
    s_add_u32 s48, s48, s61
    s_mul_i32 s48, s48, 6144
    s_add_u32 s48, s48, 7077888
    v_lshlrev_b32 v12, 7, v1
    s_mov_b32 exec_hi, 0xffff
    buffer_load_dword v100, v12, s[24:27], s48 offen sc1
    s_mov_b64 exec, -1
    v_lshlrev_b32 v12, 7, v1
    s_mov_b64 exec, -1
L_exit:
    s_endpgm
L_code_end:
.section .rodata,"a"
.p2align 6
.amdhsa_kernel gated_mix__grouped_kv_mqa__ssm_conv_s5__prompt_kernel
  .amdhsa_next_free_vgpr 256
  .amdhsa_next_free_sgpr 102
  .amdhsa_accum_offset 256
  .amdhsa_group_segment_fixed_size 0
  .amdhsa_kernarg_size 144
  .amdhsa_user_sgpr_count 2
  .amdhsa_user_sgpr_kernarg_segment_ptr 1
  .amdhsa_system_sgpr_workgroup_id_x 1
.end_amdhsa_kernel
```
